```python
import torch

def _softmax(x, axis=-1):
    return torch.softmax(x, dim=axis)
def _gelu(x):
    return torch.nn.functional.gelu(x, approximate="tanh")
def _silu(x):
    return torch.nn.functional.silu(x)
def _sigmoid(x):
    return torch.sigmoid(x)
def _layernorm(x, axis=-1, eps=1e-5):
    m = x.mean(dim=axis, keepdim=True)
    v = x.var(dim=axis, keepdim=True, unbiased=False)
    return (x - m) / torch.sqrt(v + eps)
def _scatter_add(tgt, idx, src, axis=0):
    return tgt.clone().index_add_(axis, idx, src)
def _segment_sum(src, seg, n):
    out = torch.zeros((n,) + src.shape[1:], dtype=src.dtype)
    return out.index_add_(0, seg, src)
def _pad(x, pw):
    flat = tuple(v for pair in reversed(pw) for v in pair)
    return torch.nn.functional.pad(x, flat)

kernel_name = 'recurrent_scan__gqa_block_cached__swiglu_ffn__decode'

def setup_inputs():

    _w = (lambda a: (lambda t: t.to(torch.bfloat16) if t.is_floating_point() else t)(torch.as_tensor(a)))
    def _A_setup():
        B, Sq, D = 1, 1, 576
        Hq, Hkv, Sk, Dh = 32, 16, 8192, 128
        assert Hq % Hkv == 0, (Hq, Hkv)
        return {
            "x": _w((lambda *s: torch.randn(*s, dtype=torch.bfloat16) * 0.05)(B, Sq, D)),
            "k_cache": _w((lambda *s: torch.randn(*s, dtype=torch.bfloat16) * 1.6)(B, Hkv, Sk, Dh)),
            "v_cache": _w((lambda *s: torch.randn(*s, dtype=torch.bfloat16) * 0.2)(B, Hkv, Sk, Dh)),
            "wq": _w((lambda *s: torch.randn(*s, dtype=torch.bfloat16) * 1.6)(D, Hq * Dh) * (D ** -0.5)),
            "wo": _w((lambda *s: torch.randn(*s, dtype=torch.bfloat16) * 0.2)(Hq * Dh, D) * ((Hq * Dh) ** -0.5)),
        }
    _A_in = _A_setup()

    def _B_setup():
        B, S, D, F = 1, 1, 576, 4608
        return {
            "x": _w((lambda *s: torch.randn(*s, dtype=torch.bfloat16) * 0.05)(B, S, D)),
            "w_gate": _w((lambda *s: torch.randn(*s, dtype=torch.bfloat16) * 0.1)(D, F)),
            "w_up": _w((lambda *s: torch.randn(*s, dtype=torch.bfloat16) * 0.1)(D, F)),
            "w_down": _w((lambda *s: torch.randn(*s, dtype=torch.bfloat16) * 0.1)(F, D)),
        }
    _B_in = _B_setup()

    return {
        "A_x": _A_in["x"],
        "A_k_cache": _A_in["k_cache"],
        "A_v_cache": _A_in["v_cache"],
        "A_wq": _A_in["wq"],
        "A_wo": _A_in["wo"],
        "B_x": _B_in["x"],
        "B_w_gate": _B_in["w_gate"],
        "B_w_up": _B_in["w_up"],
        "B_w_down": _B_in["w_down"],
    }

def reference(A_x, A_k_cache, A_v_cache, A_wq, A_wo, B_x, B_w_gate, B_w_up, B_w_down):
    def _A_ref(x, k_cache, v_cache, wq, wo):
        B, Sq, D = x.shape
        Hq, Dh = 32, 128
        Hkv = k_cache.shape[1]
        rep = Hq // Hkv
        q = (lambda x, *d: x.permute(*d))((x @ wq).reshape(B, Sq, Hq, Dh), 0, 2, 1, 3)
        k = (lambda x, n, axis: torch.repeat_interleave(x, n, dim=axis))(k_cache, rep, axis=1)
        v = (lambda x, n, axis: torch.repeat_interleave(x, n, dim=axis))(v_cache, rep, axis=1)
        scores = torch.einsum("bhqd,bhkd->bhqk", q, k) * (Dh ** -0.5)
        p = _softmax(scores, axis=-1)
        o = torch.einsum("bhqk,bhkd->bhqd", p, v)
        return (lambda x, *d: x.permute(*d))(o, 0, 2, 1, 3).reshape(B, Sq, Hq * Dh) @ wo

    def _B_ref(x, w_gate, w_up, w_down):
        g = _silu(x @ w_gate)
        u = x @ w_up
        return (g * u) @ w_down

    x = A_x
    xn = _layernorm(x, axis=-1)
    s = _A_ref(xn, A_k_cache, A_v_cache, A_wq, A_wo)
    g = _silu(_B_ref(xn, B_w_gate, B_w_up, B_w_down))
    return x + s * g
```

```asm
; @launch grid=(256,1,1) block=(1024,1,1) lds=33024
.amdgcn_target "amdgcn-amd-amdhsa--gfx950"
.text
.globl recurrent_scan__gqa_block_cached__swiglu_ffn__decode_kernel
.p2align 8
.type recurrent_scan__gqa_block_cached__swiglu_ffn__decode_kernel,@function
recurrent_scan__gqa_block_cached__swiglu_ffn__decode_kernel:
    s_cmp_ge_u32 s2, 256
    s_cbranch_scc1 L_end
    s_load_dwordx16 s[4:19], s[0:1], 0
    s_load_dwordx8 s[20:27], s[0:1], 64
    v_lshrrev_b32_e64 v9, 6, v0
    v_and_b32_e64 v0, 63, v0
    v_readfirstlane_b32 s3, v9
    v_lshlrev_b32 v1, 4, v0
    v_lshrrev_b32 v10, 4, v0
    v_bfe_u32 v11, v0, 2, 2
    v_and_b32 v12, 3, v0
    v_lshlrev_b32 v2, 8, v11
    v_lshl_add_u32 v2, v10, 6, v2
    v_lshl_add_u32 v2, v12, 4, v2
    s_lshr_b32 s62, s2, 4
    s_add_u32 s61, s2, s62
    s_and_b32 s61, s61, 15
    s_mov_b32 s30, 33554432
    s_mov_b32 s31, 0x20000
    s_mov_b32 s34, 33554432
    s_mov_b32 s35, 0x20000
    s_mov_b32 s38, 16777216
    s_mov_b32 s39, 0x20000
    s_mov_b32 s46, 1152
    s_mov_b32 s47, 0x20000
    s_mov_b32 s43, 0x20000
    s_mov_b32 s51, 0x20000
    v_and_b32 v13, 7, v0
    v_lshrrev_b32 v14, 3, v0
    s_and_b32 s65, s61, 7
    s_lshr_b32 s66, s61, 3
    s_mul_i32 s67, s65, 9
    s_add_u32 s67, s67, s62
    s_lshl2_add_u32 s68, s61, s62
    s_sub_u32 s68, s68, 9
    s_lshl_b32 s72, s68, 10
    s_add_u32 s72, s72, 4096
    s_and_b32 s71, s67, 3
    s_lshl1_add_u32 s71, s71, s66
    s_mul_i32 s71, s71, 18
    s_lshr_b32 s65, s67, 2
    s_add_u32 s71, s71, s65
    s_lshl_b32 s71, s71, 10
    s_add_u32 s71, s71, 69632
    s_cmp_lt_u32 s62, 9
    s_cselect_b32 s67, s67, s68
    s_cselect_b32 s71, s71, s72
    s_movk_i32 s69, 8192
    s_cselect_b32 s69, 9216, s69
    s_mul_i32 s42, s69, 576
    s_and_b32 s65, s67, 3
    s_lshl3_add_u32 s65, s65, s3
    s_mul_i32 s65, s65, 18
    s_mul_i32 s68, s65, s69
    s_lshr_b32 s67, s67, 2
    s_lshl_b32 s67, s67, 9
    s_add_u32 s68, s68, s67
    v_lshrrev_b32 v15, 5, v0
    v_and_b32 v16, 31, v0
    v_mul_u32_u24 v3, s69, v15
    v_lshl_add_u32 v3, v16, 4, v3
    s_lshl_b32 s69, s69, 1
    v_lshlrev_b32 v17, 1, v0
    s_waitcnt lgkmcnt(0)
    s_mov_b32 s28, s6
    s_and_b32 s29, s7, 0xffff
    s_mov_b32 s44, s4
    s_and_b32 s45, s5, 0xffff
    s_cmp_ge_u32 s3, 8
    s_cbranch_scc1 L_RK
    s_cmp_ge_u32 s62, 13
    s_cbranch_scc1 L_RK
    s_setprio 3
    s_load_dword s60, s[26:27], 0
    s_cmp_lg_u32 s66, 0
    s_cselect_b32 s40, s18, s16
    s_cselect_b32 s41, s19, s17
    s_cmp_lt_u32 s62, 9
    s_cselect_b32 s40, s40, s10
    s_cselect_b32 s41, s41, s11
    s_and_b32 s41, s41, 0xffff
    buffer_load_dwordx4 v[32:35], v1, s[44:47], 0 offen
    buffer_load_ushort v28, v17, s[44:47], 0 offen offset:1024
    buffer_load_dwordx4 v[52:55], v3, s[40:43], s68 offen nt
    s_add_u32 s68, s68, s69
    buffer_load_dwordx4 v[56:59], v3, s[40:43], s68 offen nt
    s_add_u32 s68, s68, s69
    buffer_load_dwordx4 v[60:63], v3, s[40:43], s68 offen nt
    s_add_u32 s68, s68, s69
    buffer_load_dwordx4 v[64:67], v3, s[40:43], s68 offen nt
    s_add_u32 s68, s68, s69
    buffer_load_dwordx4 v[68:71], v3, s[40:43], s68 offen nt
    s_add_u32 s68, s68, s69
    buffer_load_dwordx4 v[72:75], v3, s[40:43], s68 offen nt
    s_add_u32 s68, s68, s69
    buffer_load_dwordx4 v[76:79], v3, s[40:43], s68 offen nt
    s_add_u32 s68, s68, s69
    buffer_load_dwordx4 v[80:83], v3, s[40:43], s68 offen nt
    s_add_u32 s68, s68, s69
    buffer_load_dwordx4 v[84:87], v3, s[40:43], s68 offen nt
    s_barrier
    s_mov_b32 s32, s8
    s_and_b32 s33, s9, 0xffff
    s_mov_b32 s36, s26
    s_and_b32 s37, s27, 0xffff
    v_and_b32 v15, 1, v0
    v_lshlrev_b32 v15, 4, v15
    v_mov_b32 v16, 0xffff
    v_lshlrev_b32 v15, v15, v16
    v_lshrrev_b32 v16, 1, v13
    v_cmp_eq_u32 vcc, 0, v16
    s_nop 1
    v_cndmask_b32 v4, 0, v15, vcc
    v_cmp_eq_u32 vcc, 1, v16
    s_nop 1
    v_cndmask_b32 v5, 0, v15, vcc
    v_cmp_eq_u32 vcc, 2, v16
    s_nop 1
    v_cndmask_b32 v6, 0, v15, vcc
    v_cmp_eq_u32 vcc, 3, v16
    s_nop 1
    v_cndmask_b32 v7, 0, v15, vcc
    s_lshl_b32 s58, s62, 3
    s_cmp_ge_u32 s62, 8
    s_mov_b32 s56, 0x3020100
    s_cselect_b32 s56, 0x9090908, s56
    s_mov_b32 s57, 0x7060504
    s_cselect_b32 s57, 0x50a0f09, s57
    s_lshr_b64 s[56:57], s[56:57], s58
    s_sext_i32_i8 s63, s56
    s_cmp_ge_u32 s62, 8
    s_mov_b32 s56, 0x1010101
    s_cselect_b32 s56, 0x1, s56
    s_mov_b32 s57, 0x1010101
    s_cselect_b32 s57, 0xfbfbfb06, s57
    s_lshr_b64 s[56:57], s[56:57], s58
    s_sext_i32_i8 s16, s56
    s_lshl_b32 s58, s2, 3
    s_mov_b32 s56, 0x40004
    s_mov_b32 s57, 0xfc00fc00
    s_lshr_b64 s[56:57], s[56:57], s58
    s_sext_i32_i8 s59, s56
    s_add_i32 s16, s16, s59
    s_mov_b32 s56, 0x8080404
    s_mov_b32 s57, 0x40408
    s_lshr_b64 s[56:57], s[56:57], s58
    s_sext_i32_i8 s59, s56
    s_sub_i32 s63, s63, s59
    s_lshl_b32 s58, s61, 3
    s_mov_b32 s56, 0x8080404
    s_mov_b32 s57, 0x40408
    s_lshr_b64 s[56:57], s[56:57], s58
    s_sext_i32_i8 s59, s56
    s_add_i32 s63, s63, s59
    s_lshl4_add_u32 s58, s61, s62
    s_lshl4_add_u32 s58, s58, s3
    s_lshl3_add_u32 s63, s58, s63
    s_min_i32 s58, s3, s16
    s_max_i32 s58, s58, 0
    s_add_i32 s63, s63, s58
    s_sub_i32 s58, s3, s16
    s_sub_i32 s59, s58, 16
    s_max_i32 s59, s59, 0
    s_sub_i32 s63, s63, s59
    s_lshl_b32 s63, s63, 10
    s_ashr_i32 s58, s58, 4
    s_sub_i32 s16, 8, s58
    s_add_u32 s64, s63, 4096
    s_add_u32 s17, s63, 8192
    s_waitcnt vmcnt(9)
    v_lshlrev_b32 v20, 16, v32
    v_and_b32 v21, 0xffff0000, v32
    v_lshlrev_b32 v22, 16, v33
    v_and_b32 v23, 0xffff0000, v33
    v_lshlrev_b32 v24, 16, v34
    v_and_b32 v25, 0xffff0000, v34
    v_lshlrev_b32 v26, 16, v35
    v_and_b32 v27, 0xffff0000, v35
    v_lshlrev_b32 v28, 16, v28
    v_add_f32 v30, v20, v21
    v_add_f32 v30, v30, v22
    v_add_f32 v30, v30, v23
    v_add_f32 v30, v30, v24
    v_add_f32 v30, v30, v25
    v_add_f32 v30, v30, v26
    v_add_f32 v30, v30, v27
    v_add_f32 v30, v30, v28
    s_nop 1
    v_add_f32_dpp v30, v30, v30 quad_perm:[1,0,3,2] row_mask:0xf bank_mask:0xf
    s_nop 1
    v_add_f32_dpp v30, v30, v30 quad_perm:[2,3,0,1] row_mask:0xf bank_mask:0xf
    s_nop 1
    v_add_f32_dpp v30, v30, v30 row_half_mirror row_mask:0xf bank_mask:0xf
    s_nop 1
    v_add_f32_dpp v30, v30, v30 row_mirror row_mask:0xf bank_mask:0xf
    v_mov_b32 v31, v30
    s_nop 1
    v_permlane16_swap_b32 v31, v30
    v_add_f32 v30, v30, v31
    v_mov_b32 v31, v30
    s_nop 1
    v_permlane32_swap_b32 v31, v30
    v_add_f32 v30, v30, v31
    v_mul_f32 v30, 0x3ae38e39, v30
    v_sub_f32 v31, v20, v30
    v_mul_f32 v32, v31, v31
    v_sub_f32 v31, v21, v30
    v_fmac_f32 v32, v31, v31
    v_sub_f32 v31, v22, v30
    v_fmac_f32 v32, v31, v31
    v_sub_f32 v31, v23, v30
    v_fmac_f32 v32, v31, v31
    v_sub_f32 v31, v24, v30
    v_fmac_f32 v32, v31, v31
    v_sub_f32 v31, v25, v30
    v_fmac_f32 v32, v31, v31
    v_sub_f32 v31, v26, v30
    v_fmac_f32 v32, v31, v31
    v_sub_f32 v31, v27, v30
    v_fmac_f32 v32, v31, v31
    v_sub_f32 v31, v28, v30
    v_fmac_f32 v32, v31, v31
    s_nop 1
    v_add_f32_dpp v32, v32, v32 quad_perm:[1,0,3,2] row_mask:0xf bank_mask:0xf
    s_nop 1
    v_add_f32_dpp v32, v32, v32 quad_perm:[2,3,0,1] row_mask:0xf bank_mask:0xf
    s_nop 1
    v_add_f32_dpp v32, v32, v32 row_half_mirror row_mask:0xf bank_mask:0xf
    s_nop 1
    v_add_f32_dpp v32, v32, v32 row_mirror row_mask:0xf bank_mask:0xf
    v_mov_b32 v31, v32
    s_nop 1
    v_permlane16_swap_b32 v31, v32
    v_add_f32 v32, v32, v31
    v_mov_b32 v31, v32
    s_nop 1
    v_permlane32_swap_b32 v31, v32
    v_add_f32 v32, v32, v31
    v_mul_f32 v32, 0x3ae38e39, v32
    v_cvt_pk_bf16_f32 v30, v30, v30
    v_and_b32 v30, 0xffff0000, v30
    v_cvt_pk_bf16_f32 v32, v32, v32
    v_and_b32 v32, 0xffff0000, v32
    v_add_f32 v32, 0x3727c5ac, v32
    v_cvt_pk_bf16_f32 v32, v32, v32
    v_and_b32 v32, 0xffff0000, v32
    v_sqrt_f32 v32, v32
    s_nop 0
    v_cvt_pk_bf16_f32 v32, v32, v32
    v_and_b32 v32, 0xffff0000, v32
    v_rcp_f32 v32, v32
    v_lshlrev_b32 v17, 2, v0
    v_lshlrev_b32 v18, 5, v0
    v_sub_f32 v20, v20, v30
    v_sub_f32 v21, v21, v30
    v_sub_f32 v22, v22, v30
    v_sub_f32 v23, v23, v30
    v_sub_f32 v24, v24, v30
    v_sub_f32 v25, v25, v30
    v_sub_f32 v26, v26, v30
    v_sub_f32 v27, v27, v30
    v_sub_f32 v28, v28, v30
    v_cvt_pk_bf16_f32 v20, v20, v20
    v_and_b32 v20, 0xffff0000, v20
    v_cvt_pk_bf16_f32 v21, v21, v21
    v_and_b32 v21, 0xffff0000, v21
    v_cvt_pk_bf16_f32 v22, v22, v22
    v_and_b32 v22, 0xffff0000, v22
    v_cvt_pk_bf16_f32 v23, v23, v23
    v_and_b32 v23, 0xffff0000, v23
    v_cvt_pk_bf16_f32 v24, v24, v24
    v_and_b32 v24, 0xffff0000, v24
    v_cvt_pk_bf16_f32 v25, v25, v25
    v_and_b32 v25, 0xffff0000, v25
    v_cvt_pk_bf16_f32 v26, v26, v26
    v_and_b32 v26, 0xffff0000, v26
    v_cvt_pk_bf16_f32 v27, v27, v27
    v_and_b32 v27, 0xffff0000, v27
    v_cvt_pk_bf16_f32 v28, v28, v28
    v_and_b32 v28, 0xffff0000, v28
    v_mul_f32 v20, v20, v32
    v_cvt_pk_bf16_f32 v20, v20, v20
    v_mul_f32 v21, v21, v32
    v_cvt_pk_bf16_f32 v21, v21, v21
    v_mul_f32 v22, v22, v32
    v_cvt_pk_bf16_f32 v22, v22, v22
    v_mul_f32 v23, v23, v32
    v_cvt_pk_bf16_f32 v23, v23, v23
    ds_write_b128 v18, v[20:23] offset:0
    v_mul_f32 v24, v24, v32
    v_cvt_pk_bf16_f32 v24, v24, v24
    v_mul_f32 v25, v25, v32
    v_cvt_pk_bf16_f32 v25, v25, v25
    v_mul_f32 v26, v26, v32
    v_cvt_pk_bf16_f32 v26, v26, v26
    v_mul_f32 v27, v27, v32
    v_cvt_pk_bf16_f32 v27, v27, v27
    ds_write_b128 v18, v[24:27] offset:16
    v_mul_f32 v28, v28, v32
    v_cvt_pk_bf16_f32 v28, v28, v28
    ds_write_b32 v17, v28 offset:2048
    s_lshl_b32 s72, s65, 2
    v_lshrrev_b32 v18, 5, v0
    v_lshl_add_u32 v18, v18, 2, s72
    ds_read2_b32 v[20:21], v18 offset0:0 offset1:2
    ds_read2_b32 v[22:23], v18 offset0:4 offset1:6
    ds_read2_b32 v[24:25], v18 offset0:8 offset1:10
    ds_read2_b32 v[26:27], v18 offset0:12 offset1:14
    ds_read2_b32 v[28:29], v18 offset0:16 offset1:18
    s_mov_b32 vcc_lo, 0xff0000ff
    s_mov_b32 vcc_hi, 0xff0000ff
    v_cndmask_b32 v36, 0, v4, vcc
    v_cndmask_b32 v37, 0, v5, vcc
    v_cndmask_b32 v38, 0, v6, vcc
    v_cndmask_b32 v39, 0, v7, vcc
    s_lshl_b32 s72, s3, 10
    v_add_u32 v19, s72, v1
    v_and_b32 v17, 32, v0
    v_bfe_u32 v18, v0, 1, 4
    v_add_u32 v17, v17, v18
    v_and_b32 v18, 1, v0
    v_lshl_add_u32 v17, v18, 4, v17
    v_lshlrev_b32 v17, 4, v17
    v_mov_b32 v18, 1
    v_mov_b32 v16, 0
    s_waitcnt lgkmcnt(0)
    s_mul_i32 s60, s60, 0x9E3779B1
    s_add_u32 s60, s60, 0x7F4A7C15
    v_and_b32 v40, v20, v36
    v_and_b32 v41, v20, v37
    v_and_b32 v42, v20, v38
    v_and_b32 v43, v20, v39
    s_waitcnt vmcnt(8)
    s_nop 0
    v_mfma_f32_16x16x32_bf16 v[48:51], v[40:43], v[52:55], 0
    v_and_b32 v44, v21, v36
    v_and_b32 v45, v21, v37
    v_and_b32 v46, v21, v38
    v_and_b32 v47, v21, v39
    s_waitcnt vmcnt(7)
    s_nop 0
    v_mfma_f32_16x16x32_bf16 v[48:51], v[44:47], v[56:59], v[48:51]
    v_and_b32 v40, v22, v36
    v_and_b32 v41, v22, v37
    v_and_b32 v42, v22, v38
    v_and_b32 v43, v22, v39
    s_waitcnt vmcnt(6)
    s_nop 0
    v_mfma_f32_16x16x32_bf16 v[48:51], v[40:43], v[60:63], v[48:51]
    v_and_b32 v44, v23, v36
    v_and_b32 v45, v23, v37
    v_and_b32 v46, v23, v38
    v_and_b32 v47, v23, v39
    s_waitcnt vmcnt(5)
    s_nop 0
    v_mfma_f32_16x16x32_bf16 v[48:51], v[44:47], v[64:67], v[48:51]
    v_and_b32 v40, v24, v36
    v_and_b32 v41, v24, v37
    v_and_b32 v42, v24, v38
    v_and_b32 v43, v24, v39
    s_waitcnt vmcnt(4)
    s_nop 0
    v_mfma_f32_16x16x32_bf16 v[48:51], v[40:43], v[68:71], v[48:51]
    v_and_b32 v44, v25, v36
    v_and_b32 v45, v25, v37
    v_and_b32 v46, v25, v38
    v_and_b32 v47, v25, v39
    s_waitcnt vmcnt(3)
    s_nop 0
    v_mfma_f32_16x16x32_bf16 v[48:51], v[44:47], v[72:75], v[48:51]
    v_and_b32 v40, v26, v36
    v_and_b32 v41, v26, v37
    v_and_b32 v42, v26, v38
    v_and_b32 v43, v26, v39
    s_waitcnt vmcnt(2)
    s_nop 0
    v_mfma_f32_16x16x32_bf16 v[48:51], v[40:43], v[76:79], v[48:51]
    v_and_b32 v44, v27, v36
    v_and_b32 v45, v27, v37
    v_and_b32 v46, v27, v38
    v_and_b32 v47, v27, v39
    s_waitcnt vmcnt(1)
    s_nop 0
    v_mfma_f32_16x16x32_bf16 v[48:51], v[44:47], v[80:83], v[48:51]
    v_and_b32 v40, v28, v36
    v_and_b32 v41, v28, v37
    v_and_b32 v42, v28, v38
    v_and_b32 v43, v28, v39
    s_waitcnt vmcnt(0)
    s_nop 0
    v_mfma_f32_16x16x32_bf16 v[48:51], v[40:43], v[84:87], v[48:51]
    s_nop 7
    ds_write_b128 v19, v[48:51] offset:4096
    s_mov_b64 exec, 1
    ds_add_rtn_u32 v18, v16, v18 offset:3328
    s_mov_b64 exec, -1
    s_waitcnt lgkmcnt(0)
    v_readfirstlane_b32 s72, v18
    s_cmp_lg_u32 s72, 7
    s_cbranch_scc1 L_K
    ds_read_b128 v[52:55], v17 offset:4096
    ds_read_b128 v[56:59], v17 offset:5120
    ds_read_b128 v[60:63], v17 offset:6144
    ds_read_b128 v[64:67], v17 offset:7168
    ds_read_b128 v[68:71], v17 offset:8192
    ds_read_b128 v[72:75], v17 offset:9216
    ds_read_b128 v[76:79], v17 offset:10240
    ds_read_b128 v[80:83], v17 offset:11264
    v_lshlrev_b32 v20, 3, v12
    v_lshrrev_b32 v20, v20, s60
    v_lshrrev_b32 v21, 2, v20
    v_lshrrev_b32 v22, 4, v20
    v_lshrrev_b32 v23, 6, v20
    s_waitcnt lgkmcnt(6)
    v_pk_add_f32 v[52:53], v[52:53], v[56:57]
    v_pk_add_f32 v[54:55], v[54:55], v[58:59]
    s_waitcnt lgkmcnt(4)
    v_pk_add_f32 v[60:61], v[60:61], v[64:65]
    v_pk_add_f32 v[62:63], v[62:63], v[66:67]
    v_pk_add_f32 v[52:53], v[52:53], v[60:61]
    v_pk_add_f32 v[54:55], v[54:55], v[62:63]
    s_waitcnt lgkmcnt(2)
    v_pk_add_f32 v[68:69], v[68:69], v[72:73]
    v_pk_add_f32 v[70:71], v[70:71], v[74:75]
    s_waitcnt lgkmcnt(0)
    v_pk_add_f32 v[76:77], v[76:77], v[80:81]
    v_pk_add_f32 v[78:79], v[78:79], v[82:83]
    v_pk_add_f32 v[68:69], v[68:69], v[76:77]
    v_pk_add_f32 v[70:71], v[70:71], v[78:79]
    v_pk_add_f32 v[52:53], v[52:53], v[68:69]
    v_pk_add_f32 v[54:55], v[54:55], v[70:71]
    v_bfi_b32 v52, 3, v20, v52
    v_bfi_b32 v53, 3, v21, v53
    v_bfi_b32 v54, 3, v22, v54
    v_bfi_b32 v55, 3, v23, v55
    buffer_store_dwordx4 v[52:55], v1, s[36:39], s71 offen sc1
    s_branch L_K
L_RK:
    v_mov_b32 v16, 0
    v_mov_b32 v17, 0
    v_lshlrev_b32 v18, 3, v0
    ds_write_b64 v18, v[16:17] offset:3072
    s_lshr_b32 s56, s2, 3
    s_lshl_b32 s56, s56, 7
    s_add_u32 s56, s56, 442368
    s_add_u32 s57, s56, 8192
    s_cmp_lt_u32 s2, 64
    s_cselect_b32 s58, s3, 0
    s_cmp_lg_u32 s58, 8
    s_waitcnt lgkmcnt(0)
    s_cbranch_scc1 L_nr0
    s_load_dword s19, s[26:27], s56
    s_load_dwordx2 s[14:15], s[26:27], s57
L_nr0:
    s_lshl_b32 s58, s62, 3
    s_cmp_ge_u32 s62, 8
    s_mov_b32 s56, 0x3020100
    s_cselect_b32 s56, 0x9090908, s56
    s_mov_b32 s57, 0x7060504
    s_cselect_b32 s57, 0x50a0f09, s57
    s_lshr_b64 s[56:57], s[56:57], s58
    s_sext_i32_i8 s63, s56
    s_cmp_ge_u32 s62, 8
    s_mov_b32 s56, 0x1010101
    s_cselect_b32 s56, 0x1, s56
    s_mov_b32 s57, 0x1010101
    s_cselect_b32 s57, 0xfbfbfb06, s57
    s_lshr_b64 s[56:57], s[56:57], s58
    s_sext_i32_i8 s16, s56
    s_lshl_b32 s58, s2, 3
    s_mov_b32 s56, 0x40004
    s_mov_b32 s57, 0xfc00fc00
    s_lshr_b64 s[56:57], s[56:57], s58
    s_sext_i32_i8 s59, s56
    s_add_i32 s16, s16, s59
    s_mov_b32 s56, 0x8080404
    s_mov_b32 s57, 0x40408
    s_lshr_b64 s[56:57], s[56:57], s58
    s_sext_i32_i8 s59, s56
    s_sub_i32 s63, s63, s59
    s_lshl_b32 s58, s61, 3
    s_mov_b32 s56, 0x8080404
    s_mov_b32 s57, 0x40408
    s_lshr_b64 s[56:57], s[56:57], s58
    s_sext_i32_i8 s59, s56
    s_add_i32 s63, s63, s59
    s_waitcnt lgkmcnt(2)
    s_lshl4_add_u32 s58, s61, s62
    s_lshl4_add_u32 s58, s58, s3
    s_lshl3_add_u32 s63, s58, s63
    s_min_i32 s58, s3, s16
    s_max_i32 s58, s58, 0
    s_add_i32 s63, s63, s58
    s_sub_i32 s58, s3, s16
    s_sub_i32 s59, s58, 16
    s_max_i32 s59, s59, 0
    s_sub_i32 s63, s63, s59
    s_lshl_b32 s63, s63, 10
    s_ashr_i32 s58, s58, 4
    s_sub_i32 s16, 8, s58
    s_add_u32 s64, s63, 4096
    s_add_u32 s17, s63, 8192
    s_getreg_b32 s56, hwreg(HW_REG_IB_STS, 8, 4)
    s_cmp_lg_u32 s56, 2
    s_cselect_b32 s18, 1, 0
    s_barrier
    s_load_dword s60, s[26:27], 0
    s_setprio 2
    s_cmp_lt_u32 s16, 8
    s_cbranch_scc1 KO_1
    s_cmp_eq_u32 s16, 8
    s_cbranch_scc1 KO_2
    buffer_load_dwordx4 v[100:103], v2, s[28:31], s17 offen offset:0 nt
KO_2:
    buffer_load_dwordx4 v[20:23], v2, s[28:31], s64 offen offset:3072 nt
KO_1:
    buffer_load_dwordx4 v[24:27], v2, s[28:31], s63 offen offset:0 nt
    buffer_load_dwordx4 v[28:31], v2, s[28:31], s63 offen offset:1024 nt
    buffer_load_dwordx4 v[32:35], v2, s[28:31], s63 offen offset:2048 nt
    buffer_load_dwordx4 v[36:39], v2, s[28:31], s63 offen offset:3072 nt
    buffer_load_dwordx4 v[40:43], v2, s[28:31], s64 offen offset:0 nt
    buffer_load_dwordx4 v[44:47], v2, s[28:31], s64 offen offset:1024 nt
    buffer_load_dwordx4 v[48:51], v2, s[28:31], s64 offen offset:2048 nt
    s_mov_b32 s32, s8
    s_and_b32 s33, s9, 0xffff
    s_mov_b32 s36, s26
    s_and_b32 s37, s27, 0xffff
    v_and_b32 v15, 1, v0
    v_lshlrev_b32 v15, 4, v15
    v_mov_b32 v16, 0xffff
    v_lshlrev_b32 v15, v15, v16
    v_lshrrev_b32 v16, 1, v13
    v_cmp_eq_u32 vcc, 0, v16
    s_nop 1
    v_cndmask_b32 v4, 0, v15, vcc
    v_cmp_eq_u32 vcc, 1, v16
    s_nop 1
    v_cndmask_b32 v5, 0, v15, vcc
    v_cmp_eq_u32 vcc, 2, v16
    s_nop 1
    v_cndmask_b32 v6, 0, v15, vcc
    v_cmp_eq_u32 vcc, 3, v16
    s_nop 1
    v_cndmask_b32 v7, 0, v15, vcc
    s_waitcnt lgkmcnt(0)
    s_mul_i32 s60, s60, 0x9E3779B1
    s_add_u32 s60, s60, 0x7F4A7C15
    s_cmp_lg_u32 s3, 8
    s_cbranch_scc1 L_V
    s_cmp_ge_u32 s2, 64
    s_cbranch_scc1 L_V
    s_getreg_b32 s56, hwreg(HW_REG_XCC_ID, 2, 1)
    s_xor_b32 s18, s18, s56
    s_xor_b32 s56, s18, s60
    v_mov_b32 v16, s56
    s_lshl_b32 s56, s2, 2
    s_mov_b64 exec, 1
    buffer_store_dword v16, off, s[36:39], s56 offset:256 sc1
    s_mov_b64 exec, -1
    s_branch L_V
L_K:
    s_setprio 2
    s_cmp_lt_u32 s16, 8
    s_cbranch_scc1 KO_3
    s_cmp_eq_u32 s16, 8
    s_cbranch_scc1 KO_4
    buffer_load_dwordx4 v[100:103], v2, s[28:31], s17 offen offset:0 nt
KO_4:
    buffer_load_dwordx4 v[20:23], v2, s[28:31], s64 offen offset:3072 nt
KO_3:
    buffer_load_dwordx4 v[24:27], v2, s[28:31], s63 offen offset:0 nt
    buffer_load_dwordx4 v[28:31], v2, s[28:31], s63 offen offset:1024 nt
    buffer_load_dwordx4 v[32:35], v2, s[28:31], s63 offen offset:2048 nt
    buffer_load_dwordx4 v[36:39], v2, s[28:31], s63 offen offset:3072 nt
    buffer_load_dwordx4 v[40:43], v2, s[28:31], s64 offen offset:0 nt
    buffer_load_dwordx4 v[44:47], v2, s[28:31], s64 offen offset:1024 nt
    buffer_load_dwordx4 v[48:51], v2, s[28:31], s64 offen offset:2048 nt
L_V:
    s_mul_i32 s65, s62, 11
    s_lshr_b32 s65, s65, 5
    s_lshl2_add_u32 s59, s65, s3
    s_add_u32 s59, s59, 4
    s_and_b32 s59, s59, 15
    s_mul_i32 s66, s65, 3
    s_sub_u32 s66, s62, s66
    s_lshl4_add_u32 s69, s62, s61
    s_sub_u32 s69, s69, 208
    s_cmp_ge_u32 s62, 13
    s_cselect_b32 s48, s20, s12
    s_cselect_b32 s49, s21, s13
    s_mov_b32 s50, 4718592
    s_cselect_b32 s50, 5308416, s50
    s_and_b32 s49, s49, 0xffff
    s_cmp_ge_u32 s3, 4
    s_cbranch_scc1 L_V2
    s_setprio 1
    v_mov_b64 v[52:53], 0
    v_mov_b64 v[54:55], 0
    v_mov_b64 v[104:105], 0
    v_mov_b64 v[106:107], 0
    s_cmp_lt_u32 s16, 8
    s_cbranch_scc1 KO_5
    s_cmp_eq_u32 s16, 8
    s_cbranch_scc1 KO_6
    buffer_load_dwordx4 v[104:107], v1, s[32:35], s17 offen offset:0 nt
KO_6:
    buffer_load_dwordx4 v[52:55], v1, s[32:35], s64 offen offset:3072 nt
KO_5:
    buffer_load_dwordx4 v[56:59], v1, s[32:35], s63 offen offset:0 nt
    buffer_load_dwordx4 v[60:63], v1, s[32:35], s63 offen offset:1024 nt
    buffer_load_dwordx4 v[64:67], v1, s[32:35], s63 offen offset:2048 nt
    buffer_load_dwordx4 v[68:71], v1, s[32:35], s63 offen offset:3072 nt
    buffer_load_dwordx4 v[72:75], v1, s[32:35], s64 offen offset:0 nt
    s_lshl4_add_u32 s67, s61, s3
    s_lshl_b32 s67, s67, 8
    s_add_u32 s67, s67, 4096
    v_and_b32 v15, 15, v0
    v_lshlrev_b32 v108, 10, v10
    v_lshl_add_u32 v108, v15, 4, v108
    s_lshl_b32 s68, s3, 7
    v_lshl_add_u32 v15, v15, 3, s68
    v_lshlrev_b32 v96, 3, v12
    v_lshrrev_b32 v96, v96, s60
    v_lshrrev_b32 v97, 2, v96
    v_lshrrev_b32 v98, 4, v96
    v_lshrrev_b32 v99, 6, v96
    s_cmp_ge_u32 s62, 13
    s_cbranch_scc1 L_qD
    s_setprio 3
    buffer_load_dwordx4 v[88:91], v108, s[36:39], s67 offen sc0 sc1
    s_setprio 1
    buffer_load_dwordx4 v[76:79], v1, s[32:35], s64 offen offset:1024 nt
    buffer_load_dwordx4 v[80:83], v1, s[32:35], s64 offen offset:2048 nt
    s_waitcnt vmcnt(2)
L_q1:
    s_setprio 3
    s_mov_b32 s70, 20000
PC_7:
    v_xor_b32 v92, v88, v96
    v_xor_b32 v93, v90, v98
    v_bitop3_b32 v92, v89, v97, v92 bitop3:0xbe
    v_bitop3_b32 v93, v91, v99, v93 bitop3:0xbe
    v_bitop3_b32 v92, v92, v93, 3 bitop3:0xa8
    v_cmp_ne_u32 vcc, 0, v92
    s_nop 0
    s_cbranch_vccnz PR_8
PD_9:
    v_and_b32 v88, -4, v88
    v_and_b32 v89, -4, v89
    v_and_b32 v90, -4, v90
    v_and_b32 v91, -4, v91
    v_mov_b32 v92, v88
    v_mov_b32 v93, v89
    v_mov_b32 v94, v90
    v_mov_b32 v95, v91
    v_permlane16_swap_b32 v92, v88
    v_permlane16_swap_b32 v93, v89
    v_permlane16_swap_b32 v94, v90
    v_permlane16_swap_b32 v95, v91
    v_pk_add_f32 v[88:89], v[88:89], v[92:93]
    v_pk_add_f32 v[90:91], v[90:91], v[94:95]
    v_mov_b32 v92, v88
    v_mov_b32 v93, v89
    v_mov_b32 v94, v90
    v_mov_b32 v95, v91
    v_permlane32_swap_b32 v92, v88
    v_permlane32_swap_b32 v93, v89
    v_permlane32_swap_b32 v94, v90
    v_permlane32_swap_b32 v95, v91
    v_pk_add_f32 v[88:89], v[88:89], v[92:93]
    v_pk_add_f32 v[90:91], v[90:91], v[94:95]
    v_cvt_pk_bf16_f32 v88, v88, v89
    v_cvt_pk_bf16_f32 v89, v90, v91
    v_mov_b32 v16, 0
    v_mov_b32 v17, 1
    s_mov_b64 exec, 0xffff
    ds_write_b64 v15, v[88:89] offset:2560
    s_mov_b64 exec, 1
    ds_add_u32 v16, v17 offset:3332
    s_mov_b64 exec, -1
    s_mov_b32 s73, 0
    s_setprio 1
    s_branch L_q
L_V2:
    s_setprio 1
    v_mov_b64 v[52:53], 0
    v_mov_b64 v[54:55], 0
    v_mov_b64 v[104:105], 0
    v_mov_b64 v[106:107], 0
    s_cmp_lt_u32 s16, 8
    s_cbranch_scc1 KO_10
    s_cmp_eq_u32 s16, 8
    s_cbranch_scc1 KO_11
    buffer_load_dwordx4 v[104:107], v1, s[32:35], s17 offen offset:0 nt
KO_11:
    buffer_load_dwordx4 v[52:55], v1, s[32:35], s64 offen offset:3072 nt
KO_10:
    buffer_load_dwordx4 v[56:59], v1, s[32:35], s63 offen offset:0 nt
    buffer_load_dwordx4 v[60:63], v1, s[32:35], s63 offen offset:1024 nt
    buffer_load_dwordx4 v[64:67], v1, s[32:35], s63 offen offset:2048 nt
    v_mul_u32_u24 v3, 1152, v14
    v_lshl_add_u32 v3, v13, 4, v3
    s_cmp_ge_u32 s62, 13
    s_cbranch_scc1 L_cD
    s_mov_b32 s73, 0
    s_cmp_eq_u32 s62, 12
    s_cbranch_scc1 L_cA
    s_cmp_lt_u32 s3, 12
    s_cbranch_scc1 L_cA
    s_mov_b32 s73, 1
    s_lshl4_add_u32 s58, s61, s59
    s_mul_i32 s58, s58, 18432
    s_mul_i32 s68, s66, 384
    s_add_u32 s58, s58, s68
    s_waitcnt vmcnt(4)
    s_cmp_eq_u32 s16, 8
    s_cbranch_scc1 L_q
    s_waitcnt vmcnt(3)
    s_branch L_q
L_cD:
    s_mov_b32 s73, 3
    s_cmp_lt_u32 s3, 7
    s_cbranch_scc1 L_cA
    s_mov_b32 s73, 2
    buffer_load_dwordx4 v[68:71], v1, s[32:35], s63 offen offset:3072 nt
    buffer_load_dwordx4 v[72:75], v1, s[32:35], s64 offen offset:0 nt
    buffer_load_dwordx4 v[76:79], v1, s[32:35], s64 offen offset:1024 nt
    buffer_load_dwordx4 v[80:83], v1, s[32:35], s64 offen offset:2048 nt
    s_mul_i32 s58, s69, 110592
    s_lshl_b32 s68, s3, 7
    s_add_u32 s58, s58, s68
    s_sub_u32 s58, s58, 896
    s_setprio 0
    buffer_load_dwordx4 v[88:91], v3, s[48:51], s58 offen nt
    s_add_u32 s58, s58, 9216
    buffer_load_dwordx4 v[92:95], v3, s[48:51], s58 offen nt
    s_add_u32 s58, s58, 9216
    buffer_load_dwordx4 v[96:99], v3, s[48:51], s58 offen nt
    s_add_u32 s58, s58, 9216
    buffer_load_dwordx4 v[100:103], v3, s[48:51], s58 offen nt
    s_add_u32 s58, s58, 9216
    buffer_load_dwordx4 v[104:107], v3, s[48:51], s58 offen nt
    s_add_u32 s58, s58, 9216
    buffer_load_dwordx4 v[108:111], v3, s[48:51], s58 offen nt
    s_add_u32 s58, s58, 9216
    s_setprio 1
    s_waitcnt vmcnt(14)
    s_cmp_eq_u32 s16, 8
    s_cbranch_scc1 L_q
    s_waitcnt vmcnt(13)
    s_branch L_q
L_cA:
    buffer_load_dwordx4 v[68:71], v1, s[32:35], s63 offen offset:3072 nt
    buffer_load_dwordx4 v[72:75], v1, s[32:35], s64 offen offset:0 nt
    buffer_load_dwordx4 v[76:79], v1, s[32:35], s64 offen offset:1024 nt
    buffer_load_dwordx4 v[80:83], v1, s[32:35], s64 offen offset:2048 nt
L_kw:
    s_waitcnt vmcnt(9)
    s_cmp_eq_u32 s16, 9
    s_cbranch_scc1 L_q
    s_waitcnt vmcnt(8)
    s_cmp_eq_u32 s16, 8
    s_cbranch_scc1 L_q
    s_waitcnt vmcnt(7)
L_q:
    v_bfe_u32 v19, v0, 3, 1
    v_lshlrev_b32 v17, 8, v19
    v_lshl_add_u32 v17, v10, 6, v17
    v_lshl_add_u32 v17, v12, 4, v17
    v_mov_b32 v16, 0
    v_mov_b32 v9, 0xffff0000
    s_mov_b32 s70, 80000
L_qs:
    ds_read_b32 v15, v16 offset:3332
    ds_read_b128 v[84:87], v17 offset:2560
    s_waitcnt lgkmcnt(0)
    v_cmp_ne_u32 vcc, 4, v15
    s_nop 0
    s_cbranch_vccnz L_qr
L_qd:
    v_mfma_f32_16x16x32_bf16 v[124:127], v[20:23], v[84:87], 0
    v_mfma_f32_16x16x32_bf16 v[20:23], v[24:27], v[84:87], 0
    v_mfma_f32_16x16x32_bf16 v[24:27], v[28:31], v[84:87], 0
    v_mfma_f32_16x16x32_bf16 v[28:31], v[32:35], v[84:87], 0
    v_mfma_f32_16x16x32_bf16 v[32:35], v[36:39], v[84:87], 0
    v_mfma_f32_16x16x32_bf16 v[36:39], v[40:43], v[84:87], 0
    v_mfma_f32_16x16x32_bf16 v[40:43], v[44:47], v[84:87], 0
    v_mfma_f32_16x16x32_bf16 v[44:47], v[48:51], v[84:87], 0
    s_lshl_b32 s68, s3, 3
    v_lshl_add_u32 v18, v19, 7, s68
    v_add_f32_dpp v124, v125, v124 quad_perm:[1,1,1,1] row_mask:0xf bank_mask:0xf
    v_add_f32_dpp v126, v127, v126 quad_perm:[3,3,3,3] row_mask:0xf bank_mask:0xf
    v_add_f32_dpp v20, v21, v20 quad_perm:[1,1,1,1] row_mask:0xf bank_mask:0xf
    v_add_f32_dpp v22, v23, v22 quad_perm:[3,3,3,3] row_mask:0xf bank_mask:0xf
    v_add_f32_dpp v24, v25, v24 quad_perm:[1,1,1,1] row_mask:0xf bank_mask:0xf
    v_add_f32_dpp v26, v27, v26 quad_perm:[3,3,3,3] row_mask:0xf bank_mask:0xf
    v_add_f32_dpp v28, v29, v28 quad_perm:[1,1,1,1] row_mask:0xf bank_mask:0xf
    v_add_f32_dpp v30, v31, v30 quad_perm:[3,3,3,3] row_mask:0xf bank_mask:0xf
    v_add_f32_dpp v32, v33, v32 quad_perm:[1,1,1,1] row_mask:0xf bank_mask:0xf
    v_add_f32_dpp v34, v35, v34 quad_perm:[3,3,3,3] row_mask:0xf bank_mask:0xf
    v_add_f32_dpp v36, v37, v36 quad_perm:[1,1,1,1] row_mask:0xf bank_mask:0xf
    v_add_f32_dpp v38, v39, v38 quad_perm:[3,3,3,3] row_mask:0xf bank_mask:0xf
    v_add_f32_dpp v40, v41, v40 quad_perm:[1,1,1,1] row_mask:0xf bank_mask:0xf
    v_add_f32_dpp v42, v43, v42 quad_perm:[3,3,3,3] row_mask:0xf bank_mask:0xf
    v_add_f32_dpp v44, v45, v44 quad_perm:[1,1,1,1] row_mask:0xf bank_mask:0xf
    v_add_f32_dpp v46, v47, v46 quad_perm:[3,3,3,3] row_mask:0xf bank_mask:0xf
    v_add_f32_dpp v124, v126, v124 quad_perm:[2,2,2,2] row_mask:0xf bank_mask:0xf
    v_add_f32_dpp v20, v22, v20 quad_perm:[2,2,2,2] row_mask:0xf bank_mask:0xf
    v_add_f32_dpp v24, v26, v24 quad_perm:[2,2,2,2] row_mask:0xf bank_mask:0xf
    v_add_f32_dpp v28, v30, v28 quad_perm:[2,2,2,2] row_mask:0xf bank_mask:0xf
    v_add_f32_dpp v32, v34, v32 quad_perm:[2,2,2,2] row_mask:0xf bank_mask:0xf
    v_add_f32_dpp v36, v38, v36 quad_perm:[2,2,2,2] row_mask:0xf bank_mask:0xf
    v_add_f32_dpp v40, v42, v40 quad_perm:[2,2,2,2] row_mask:0xf bank_mask:0xf
    v_add_f32_dpp v44, v46, v44 quad_perm:[2,2,2,2] row_mask:0xf bank_mask:0xf
    v_cvt_pk_bf16_f32 v124, v124, v124
    v_cvt_pk_bf16_f32 v20, v20, v20
    v_cvt_pk_bf16_f32 v24, v24, v24
    v_cvt_pk_bf16_f32 v28, v28, v28
    v_cvt_pk_bf16_f32 v32, v32, v32
    v_cvt_pk_bf16_f32 v36, v36, v36
    v_cvt_pk_bf16_f32 v40, v40, v40
    v_cvt_pk_bf16_f32 v44, v44, v44
    v_and_b32_dpp v112, v124, v9 quad_perm:[0,0,0,0] row_mask:0xf bank_mask:0xf
    v_and_b32_dpp v113, v20, v9 quad_perm:[0,0,0,0] row_mask:0xf bank_mask:0xf
    v_and_b32_dpp v114, v24, v9 quad_perm:[0,0,0,0] row_mask:0xf bank_mask:0xf
    v_and_b32_dpp v115, v28, v9 quad_perm:[0,0,0,0] row_mask:0xf bank_mask:0xf
    v_and_b32_dpp v116, v32, v9 quad_perm:[0,0,0,0] row_mask:0xf bank_mask:0xf
    v_and_b32_dpp v117, v36, v9 quad_perm:[0,0,0,0] row_mask:0xf bank_mask:0xf
    v_and_b32_dpp v118, v40, v9 quad_perm:[0,0,0,0] row_mask:0xf bank_mask:0xf
    v_and_b32_dpp v119, v44, v9 quad_perm:[0,0,0,0] row_mask:0xf bank_mask:0xf
    v_mul_f32 v112, 0x3db504f3, v112
    v_mul_f32 v113, 0x3db504f3, v113
    v_mul_f32 v114, 0x3db504f3, v114
    v_mul_f32 v115, 0x3db504f3, v115
    v_mul_f32 v116, 0x3db504f3, v116
    v_mul_f32 v117, 0x3db504f3, v117
    v_mul_f32 v118, 0x3db504f3, v118
    v_mul_f32 v119, 0x3db504f3, v119
    v_cvt_pk_bf16_f32 v112, v112, v112
    v_cvt_pk_bf16_f32 v113, v113, v113
    v_cvt_pk_bf16_f32 v114, v114, v114
    v_cvt_pk_bf16_f32 v115, v115, v115
    v_cvt_pk_bf16_f32 v116, v116, v116
    v_cvt_pk_bf16_f32 v117, v117, v117
    v_cvt_pk_bf16_f32 v118, v118, v118
    v_cvt_pk_bf16_f32 v119, v119, v119
    v_and_b32 v112, v9, v112
    v_and_b32 v113, v9, v113
    v_and_b32 v114, v9, v114
    v_and_b32 v115, v9, v115
    v_and_b32 v116, v9, v116
    v_and_b32 v117, v9, v117
    v_and_b32 v118, v9, v118
    v_and_b32 v119, v9, v119
    v_mov_b32 v127, 0xff800000
    s_cmp_eq_u32 s16, 8
    s_cbranch_scc1 L_n8
    s_cmp_eq_u32 s16, 9
    s_cbranch_scc1 L_n9
    v_mov_b32 v112, 0xff800000
    s_branch L_n8
L_n9:
    v_mfma_f32_16x16x32_bf16 v[48:51], v[100:103], v[84:87], 0
    s_nop 7
    v_add_f32_dpp v48, v49, v48 quad_perm:[1,1,1,1] row_mask:0xf bank_mask:0xf
    v_add_f32_dpp v50, v51, v50 quad_perm:[3,3,3,3] row_mask:0xf bank_mask:0xf
    s_nop 1
    v_add_f32_dpp v48, v50, v48 quad_perm:[2,2,2,2] row_mask:0xf bank_mask:0xf
    v_cvt_pk_bf16_f32 v48, v48, v48
    s_nop 1
    v_and_b32_dpp v127, v48, v9 quad_perm:[0,0,0,0] row_mask:0xf bank_mask:0xf
    v_mul_f32 v127, 0x3db504f3, v127
    v_cvt_pk_bf16_f32 v127, v127, v127
    v_and_b32 v127, v9, v127
L_n8:
    v_max3_f32 v124, v112, v113, v114
    v_max3_f32 v126, v115, v116, v117
    v_max3_f32 v124, v124, v118, v119
    v_max3_f32 v124, v124, v126, v127
    v_mov_b32 v126, v124
    s_nop 1
    v_permlane16_swap_b32 v126, v124
    v_max_f32 v124, v124, v126
    v_mov_b32 v126, v124
    s_nop 1
    v_permlane32_swap_b32 v126, v124
    v_max_f32 v124, v124, v126
    s_mov_b32 s72, 0x3fb8aa3b
    v_mul_f32 v124, s72, v124
    v_fma_f32 v112, v112, s72, -v124
    v_fma_f32 v113, v113, s72, -v124
    v_fma_f32 v114, v114, s72, -v124
    v_fma_f32 v115, v115, s72, -v124
    v_fma_f32 v116, v116, s72, -v124
    v_fma_f32 v117, v117, s72, -v124
    v_fma_f32 v118, v118, s72, -v124
    v_fma_f32 v119, v119, s72, -v124
    v_fma_f32 v127, v127, s72, -v124
    v_exp_f32 v112, v112
    v_exp_f32 v113, v113
    v_exp_f32 v114, v114
    v_exp_f32 v115, v115
    v_exp_f32 v116, v116
    v_exp_f32 v117, v117
    v_exp_f32 v118, v118
    v_exp_f32 v119, v119
    v_exp_f32 v127, v127
    v_add_f32 v125, v112, v113
    v_add_f32 v125, v125, v114
    v_add_f32 v125, v125, v115
    v_add_f32 v125, v125, v116
    v_add_f32 v125, v125, v117
    v_add_f32 v125, v125, v118
    v_add_f32 v125, v125, v119
    v_add_f32 v125, v125, v127
    v_mov_b32 v126, v125
    s_nop 1
    v_permlane16_swap_b32 v126, v125
    v_add_f32 v125, v125, v126
    v_mov_b32 v126, v125
    s_nop 1
    v_permlane32_swap_b32 v126, v125
    v_add_f32 v125, v125, v126
    s_mov_b64 exec, 0x101
    ds_write_b64 v18, v[124:125] offset:3072
    s_mov_b64 exec, -1
    s_cmp_lg_u32 s73, 1
    s_cbranch_scc1 L_nr
    v_lshlrev_b32 v85, 2, v0
    buffer_load_dword v84, v85, s[36:39], 0 offen offset:256 sc0 sc1
    buffer_load_dwordx4 v[68:71], v1, s[32:35], s63 offen offset:3072 nt
    buffer_load_dwordx4 v[72:75], v1, s[32:35], s64 offen offset:0 nt
    buffer_load_dwordx4 v[76:79], v1, s[32:35], s64 offen offset:1024 nt
    buffer_load_dwordx4 v[80:83], v1, s[32:35], s64 offen offset:2048 nt
    s_add_u32 s68, s58, 9216
    buffer_load_dwordx4 v[88:91], v3, s[48:51], s58 offen offset:0 nt
    buffer_load_dwordx4 v[96:99], v3, s[48:51], s58 offen offset:128 nt
    buffer_load_dwordx4 v[104:107], v3, s[48:51], s58 offen offset:256 nt
    buffer_load_dwordx4 v[92:95], v3, s[48:51], s68 offen offset:0 nt
    buffer_load_dwordx4 v[100:103], v3, s[48:51], s68 offen offset:128 nt
    buffer_load_dwordx4 v[108:111], v3, s[48:51], s68 offen offset:256 nt
L_nr:
    v_cvt_pk_bf16_f32 v112, v112, v112
    v_cvt_pk_bf16_f32 v113, v113, v113
    v_cvt_pk_bf16_f32 v114, v114, v114
    v_cvt_pk_bf16_f32 v115, v115, v115
    v_cvt_pk_bf16_f32 v116, v116, v116
    v_cvt_pk_bf16_f32 v117, v117, v117
    v_cvt_pk_bf16_f32 v118, v118, v118
    v_cvt_pk_bf16_f32 v119, v119, v119
    v_cvt_pk_bf16_f32 v127, v127, v127
    v_and_b32 v20, v112, v4
    v_and_b32 v21, v112, v5
    v_and_b32 v22, v112, v6
    v_and_b32 v23, v112, v7
    v_and_b32 v24, v113, v4
    v_and_b32 v25, v113, v5
    v_and_b32 v26, v113, v6
    v_and_b32 v27, v113, v7
    v_and_b32 v28, v114, v4
    v_and_b32 v29, v114, v5
    v_and_b32 v30, v114, v6
    v_and_b32 v31, v114, v7
    v_and_b32 v32, v115, v4
    v_and_b32 v33, v115, v5
    v_and_b32 v34, v115, v6
    v_and_b32 v35, v115, v7
    v_and_b32 v36, v116, v4
    v_and_b32 v37, v116, v5
    v_and_b32 v38, v116, v6
    v_and_b32 v39, v116, v7
    v_and_b32 v40, v117, v4
    v_and_b32 v41, v117, v5
    v_and_b32 v42, v117, v6
    v_and_b32 v43, v117, v7
    v_and_b32 v44, v118, v4
    v_and_b32 v45, v118, v5
    v_and_b32 v46, v118, v6
    v_and_b32 v47, v118, v7
    v_and_b32 v48, v119, v4
    v_and_b32 v49, v119, v5
    v_and_b32 v50, v119, v6
    v_and_b32 v51, v119, v7
    v_mov_b32 v123, s60
    v_lshrrev_b32 v17, 1, v10
    v_lshlrev_b32 v9, 7, v17
    s_lshl_b32 s68, s3, 3
    v_add_u32 v11, s68, v9
    v_lshl_add_u32 v9, v13, 4, v9
    v_lshlrev_b32 v17, 9, v17
    v_and_b32 v19, 15, v0
    v_lshl_add_u32 v17, v19, 5, v17
    v_and_b32 v19, 1, v10
    v_lshl_add_u32 v17, v19, 4, v17
    s_mul_i32 s67, s3, 1040
    v_add_u32 v17, s67, v17
    v_mul_u32_u24 v18, 2080, v13
    v_lshl_add_u32 v18, v14, 2, v18
    s_lshl_b32 s67, s59, 6
    s_add_u32 s67, s67, 8192
    v_add_u32 v18, s67, v18
    v_add_u32 v19, 1040, v18
    v_lshlrev_b32 v16, 4, v14
    s_lshl4_add_u32 s71, s61, s59
    s_and_b32 s67, s71, 0xfc
    s_add_u32 s71, s71, s67
    s_lshl_b32 s71, s71, 11
    s_add_u32 s71, s71, 1048576
    s_lshl_b32 s67, s62, 7
    s_add_u32 s57, s67, s71
    v_lshl_add_u32 v8, v13, 13, v16
    s_and_b32 s56, s59, 8
    s_lshl_b32 s56, s56, 2
    s_cmp_eq_u32 s73, 1
    s_cbranch_scc1 L_P
    s_cmp_eq_u32 s73, 2
    s_cbranch_scc1 L_D
    s_cmp_eq_u32 s73, 3
    s_cbranch_scc1 L_H
    v_and_b32 v100, v127, v4
    v_and_b32 v101, v127, v5
    v_and_b32 v102, v127, v6
    v_and_b32 v103, v127, v7
    s_waitcnt vmcnt(8)
    s_nop 0
    v_mfma_f32_16x16x32_bf16 v[124:127], v[100:103], v[104:107], 0
    s_waitcnt vmcnt(7)
    v_mfma_f32_16x16x32_bf16 v[124:127], v[20:23], v[52:55], v[124:127]
    s_waitcnt vmcnt(6)
    v_mfma_f32_16x16x32_bf16 v[124:127], v[24:27], v[56:59], v[124:127]
    s_waitcnt vmcnt(5)
    v_mfma_f32_16x16x32_bf16 v[124:127], v[28:31], v[60:63], v[124:127]
    s_waitcnt vmcnt(4)
    v_mfma_f32_16x16x32_bf16 v[124:127], v[32:35], v[64:67], v[124:127]
    s_waitcnt vmcnt(3)
    v_mfma_f32_16x16x32_bf16 v[124:127], v[36:39], v[68:71], v[124:127]
    s_waitcnt vmcnt(2)
    v_mfma_f32_16x16x32_bf16 v[124:127], v[40:43], v[72:75], v[124:127]
    s_waitcnt vmcnt(1)
    v_mfma_f32_16x16x32_bf16 v[124:127], v[44:47], v[76:79], v[124:127]
    s_mov_b32 s70, 80000
ML_12:
    ds_read_b128 v[84:87], v9 offset:3072
    ds_read_b32 v120, v11 offset:3072
    s_waitcnt lgkmcnt(0)
    v_min_u32 v121, v85, v87
    v_cmp_eq_u32 vcc, 0, v121
    s_nop 0
    s_cbranch_vccnz ML_14
ML_13:
    v_max_f32 v121, v84, v86
    s_nop 1
    v_max_f32_dpp v121, v121, v121 quad_perm:[1,0,3,2] row_mask:0xf bank_mask:0xf
    s_nop 1
    v_max_f32_dpp v121, v121, v121 quad_perm:[2,3,0,1] row_mask:0xf bank_mask:0xf
    s_nop 1
    v_max_f32_dpp v121, v121, v121 row_half_mirror row_mask:0xf bank_mask:0xf
    v_sub_f32 v120, v120, v121
    v_sub_f32 v84, v84, v121
    v_sub_f32 v86, v86, v121
    v_exp_f32 v84, v84
    v_exp_f32 v86, v86
    v_exp_f32 v120, v120
    v_mul_f32 v85, v84, v85
    v_fmac_f32 v85, v86, v87
    s_nop 1
    v_add_f32_dpp v85, v85, v85 quad_perm:[1,0,3,2] row_mask:0xf bank_mask:0xf
    s_nop 1
    v_add_f32_dpp v85, v85, v85 quad_perm:[2,3,0,1] row_mask:0xf bank_mask:0xf
    s_nop 1
    v_add_f32_dpp v85, v85, v85 row_half_mirror row_mask:0xf bank_mask:0xf
    v_rcp_f32 v84, v85
    v_log_f32 v85, v85
    v_mul_f32 v120, v120, v84
    v_add_f32 v121, v121, v85
    s_nop 0
    v_readlane_b32 s72, v121, s56
    s_nop 1
    v_mov_b32 v122, s72
    s_waitcnt vmcnt(0)
    v_mfma_f32_16x16x32_bf16 v[124:127], v[48:51], v[80:83], v[124:127]
    s_nop 7
    v_mul_f32 v124, v124, v120
    v_mul_f32 v125, v125, v120
    v_mul_f32 v126, v126, v120
    v_mul_f32 v127, v127, v120
    ds_write_b128 v17, v[124:127] offset:8192
    s_waitcnt lgkmcnt(0)
    s_barrier
    ds_read2_b32 v[120:121], v18 offset0:0 offset1:8
    ds_read2_b32 v[84:85], v19 offset0:0 offset1:8
    s_waitcnt lgkmcnt(0)
    v_add_f32 v120, v120, v84
    v_add_f32 v121, v121, v85
    s_nop 0
    v_add_f32_dpp v120, v120, v120 quad_perm:[1,0,3,2] row_mask:0xf bank_mask:0xf
    v_add_f32_dpp v121, v121, v121 quad_perm:[1,0,3,2] row_mask:0xf bank_mask:0xf
    s_nop 0
    v_add_f32_dpp v120, v120, v120 quad_perm:[2,3,0,1] row_mask:0xf bank_mask:0xf
    v_add_f32_dpp v121, v121, v121 quad_perm:[2,3,0,1] row_mask:0xf bank_mask:0xf
    s_nop 0
    v_add_f32_dpp v120, v120, v120 row_half_mirror row_mask:0xf bank_mask:0xf
    v_add_f32_dpp v121, v121, v121 row_half_mirror row_mask:0xf bank_mask:0xf
    s_mov_b32 exec_lo, 0x3030303
    s_mov_b32 exec_hi, 0x3030303
    buffer_store_dwordx4 v[120:123], v8, s[36:39], s57 offen sc1
    s_endpgm
L_H:
    v_lshrrev_b32 v108, 3, v0
    v_mul_u32_u24 v108, 18432, v108
    v_lshl_add_u32 v108, v13, 4, v108
    s_mul_i32 s68, s69, 3
    s_add_u32 s68, s68, s3
    s_lshl_b32 s68, s68, 7
    s_add_u32 s58, s68, 69120
    buffer_load_dwordx4 v[88:91], v108, s[36:39], s58 offen sc0 sc1
    v_lshlrev_b32 v96, 3, v12
    v_lshrrev_b32 v96, v96, s60
    v_lshrrev_b32 v97, 2, v96
    v_lshrrev_b32 v98, 4, v96
    v_lshrrev_b32 v99, 6, v96
    v_and_b32 v100, v127, v4
    v_and_b32 v101, v127, v5
    v_and_b32 v102, v127, v6
    v_and_b32 v103, v127, v7
    s_waitcnt vmcnt(9)
    s_nop 0
    v_mfma_f32_16x16x32_bf16 v[124:127], v[100:103], v[104:107], 0
    s_waitcnt vmcnt(8)
    v_mfma_f32_16x16x32_bf16 v[124:127], v[20:23], v[52:55], v[124:127]
    s_waitcnt vmcnt(7)
    v_mfma_f32_16x16x32_bf16 v[124:127], v[24:27], v[56:59], v[124:127]
    s_waitcnt vmcnt(6)
    v_mfma_f32_16x16x32_bf16 v[124:127], v[28:31], v[60:63], v[124:127]
    s_waitcnt vmcnt(5)
    v_mfma_f32_16x16x32_bf16 v[124:127], v[32:35], v[64:67], v[124:127]
    s_waitcnt vmcnt(4)
    v_mfma_f32_16x16x32_bf16 v[124:127], v[36:39], v[68:71], v[124:127]
    s_waitcnt vmcnt(3)
    v_mfma_f32_16x16x32_bf16 v[124:127], v[40:43], v[72:75], v[124:127]
    s_waitcnt vmcnt(2)
    v_mfma_f32_16x16x32_bf16 v[124:127], v[44:47], v[76:79], v[124:127]
    s_mov_b32 s70, 80000
ML_15:
    ds_read_b128 v[84:87], v9 offset:3072
    ds_read_b32 v120, v11 offset:3072
    s_waitcnt lgkmcnt(0)
    v_min_u32 v121, v85, v87
    v_cmp_eq_u32 vcc, 0, v121
    s_nop 0
    s_cbranch_vccnz ML_17
ML_16:
    v_max_f32 v121, v84, v86
    s_nop 1
    v_max_f32_dpp v121, v121, v121 quad_perm:[1,0,3,2] row_mask:0xf bank_mask:0xf
    s_nop 1
    v_max_f32_dpp v121, v121, v121 quad_perm:[2,3,0,1] row_mask:0xf bank_mask:0xf
    s_nop 1
    v_max_f32_dpp v121, v121, v121 row_half_mirror row_mask:0xf bank_mask:0xf
    v_sub_f32 v120, v120, v121
    v_sub_f32 v84, v84, v121
    v_sub_f32 v86, v86, v121
    v_exp_f32 v84, v84
    v_exp_f32 v86, v86
    v_exp_f32 v120, v120
    v_mul_f32 v85, v84, v85
    v_fmac_f32 v85, v86, v87
    s_nop 1
    v_add_f32_dpp v85, v85, v85 quad_perm:[1,0,3,2] row_mask:0xf bank_mask:0xf
    s_nop 1
    v_add_f32_dpp v85, v85, v85 quad_perm:[2,3,0,1] row_mask:0xf bank_mask:0xf
    s_nop 1
    v_add_f32_dpp v85, v85, v85 row_half_mirror row_mask:0xf bank_mask:0xf
    v_rcp_f32 v84, v85
    v_log_f32 v85, v85
    v_mul_f32 v120, v120, v84
    v_add_f32 v121, v121, v85
    s_nop 0
    v_readlane_b32 s72, v121, s56
    s_nop 1
    v_mov_b32 v122, s72
    s_waitcnt vmcnt(1)
    v_mfma_f32_16x16x32_bf16 v[124:127], v[48:51], v[80:83], v[124:127]
    s_nop 7
    v_mul_f32 v124, v124, v120
    v_mul_f32 v125, v125, v120
    v_mul_f32 v126, v126, v120
    v_mul_f32 v127, v127, v120
    ds_write_b128 v17, v[124:127] offset:8192
    s_lshl_b32 s68, s3, 7
    v_lshl_add_u32 v109, v13, 4, s68
    s_waitcnt vmcnt(0)
    s_mov_b32 s70, 20000
PC_18:
    v_xor_b32 v92, v88, v96
    v_xor_b32 v93, v90, v98
    v_bitop3_b32 v92, v89, v97, v92 bitop3:0xbe
    v_bitop3_b32 v93, v91, v99, v93 bitop3:0xbe
    v_bitop3_b32 v92, v92, v93, 3 bitop3:0xa8
    v_cmp_ne_u32 vcc, 0, v92
    s_nop 0
    s_cbranch_vccnz PR_19
PD_20:
    v_and_b32 v88, -4, v88
    v_and_b32 v89, -4, v89
    v_and_b32 v90, -4, v90
    v_and_b32 v91, -4, v91
    v_mov_b32 v92, v88
    v_mov_b32 v93, v89
    v_mov_b32 v94, v90
    v_mov_b32 v95, v91
    v_permlane16_swap_b32 v92, v88
    v_permlane16_swap_b32 v93, v89
    v_permlane16_swap_b32 v94, v90
    v_permlane16_swap_b32 v95, v91
    v_pk_add_f32 v[88:89], v[88:89], v[92:93]
    v_pk_add_f32 v[90:91], v[90:91], v[94:95]
    v_mov_b32 v92, v88
    v_mov_b32 v93, v89
    v_mov_b32 v94, v90
    v_mov_b32 v95, v91
    v_permlane32_swap_b32 v92, v88
    v_permlane32_swap_b32 v93, v89
    v_permlane32_swap_b32 v94, v90
    v_permlane32_swap_b32 v95, v91
    v_pk_add_f32 v[88:89], v[88:89], v[92:93]
    v_pk_add_f32 v[90:91], v[90:91], v[94:95]
    v_cvt_pk_bf16_f32 v88, v88, v88
    v_and_b32 v88, 0xffff0000, v88
    v_cvt_pk_bf16_f32 v89, v89, v89
    v_and_b32 v89, 0xffff0000, v89
    v_cvt_pk_bf16_f32 v90, v90, v90
    v_and_b32 v90, 0xffff0000, v90
    v_cvt_pk_bf16_f32 v91, v91, v91
    v_and_b32 v91, 0xffff0000, v91
    v_mov_b32_dpp v92, v88 row_ror:8 row_mask:0xf bank_mask:0xf
    v_mov_b32_dpp v93, v89 row_ror:8 row_mask:0xf bank_mask:0xf
    v_mov_b32_dpp v94, v90 row_ror:8 row_mask:0xf bank_mask:0xf
    v_mov_b32_dpp v95, v91 row_ror:8 row_mask:0xf bank_mask:0xf
    v_mul_f32 v96, 0xbfb8aa3b, v88
    v_exp_f32 v96, v96
    s_nop 0
    v_add_f32 v96, 1.0, v96
    v_rcp_f32 v96, v96
    s_nop 0
    v_mul_f32 v88, v88, v96
    v_mul_f32 v97, 0xbfb8aa3b, v89
    v_exp_f32 v97, v97
    s_nop 0
    v_add_f32 v97, 1.0, v97
    v_rcp_f32 v97, v97
    s_nop 0
    v_mul_f32 v89, v89, v97
    v_mul_f32 v98, 0xbfb8aa3b, v90
    v_exp_f32 v98, v98
    s_nop 0
    v_add_f32 v98, 1.0, v98
    v_rcp_f32 v98, v98
    s_nop 0
    v_mul_f32 v90, v90, v98
    v_mul_f32 v99, 0xbfb8aa3b, v91
    v_exp_f32 v99, v99
    s_nop 0
    v_add_f32 v99, 1.0, v99
    v_rcp_f32 v99, v99
    s_nop 0
    v_mul_f32 v91, v91, v99
    v_cvt_pk_bf16_f32 v88, v88, v88
    v_and_b32 v88, 0xffff0000, v88
    v_cvt_pk_bf16_f32 v89, v89, v89
    v_and_b32 v89, 0xffff0000, v89
    v_cvt_pk_bf16_f32 v90, v90, v90
    v_and_b32 v90, 0xffff0000, v90
    v_cvt_pk_bf16_f32 v91, v91, v91
    v_and_b32 v91, 0xffff0000, v91
    v_mul_f32 v88, v88, v92
    v_mul_f32 v89, v89, v93
    v_mul_f32 v90, v90, v94
    v_mul_f32 v91, v91, v95
    v_cvt_pk_bf16_f32 v88, v88, v88
    v_cvt_pk_bf16_f32 v89, v89, v89
    v_cvt_pk_bf16_f32 v90, v90, v90
    v_cvt_pk_bf16_f32 v91, v91, v91
    s_mov_b64 exec, 0xff
    ds_write_b128 v109, v[88:91] offset:3072
    s_mov_b64 exec, -1
    s_waitcnt lgkmcnt(0)
    s_barrier
    ds_read2_b32 v[120:121], v18 offset0:0 offset1:8
    ds_read2_b32 v[84:85], v19 offset0:0 offset1:8
    s_waitcnt lgkmcnt(0)
    v_add_f32 v120, v120, v84
    v_add_f32 v121, v121, v85
    s_nop 0
    v_add_f32_dpp v120, v120, v120 quad_perm:[1,0,3,2] row_mask:0xf bank_mask:0xf
    v_add_f32_dpp v121, v121, v121 quad_perm:[1,0,3,2] row_mask:0xf bank_mask:0xf
    s_nop 0
    v_add_f32_dpp v120, v120, v120 quad_perm:[2,3,0,1] row_mask:0xf bank_mask:0xf
    v_add_f32_dpp v121, v121, v121 quad_perm:[2,3,0,1] row_mask:0xf bank_mask:0xf
    s_nop 0
    v_add_f32_dpp v120, v120, v120 row_half_mirror row_mask:0xf bank_mask:0xf
    v_add_f32_dpp v121, v121, v121 row_half_mirror row_mask:0xf bank_mask:0xf
    s_mov_b32 exec_lo, 0x3030303
    s_mov_b32 exec_hi, 0x3030303
    buffer_store_dwordx4 v[120:123], v8, s[36:39], s57 offen sc1
    s_endpgm
L_D:
    s_waitcnt vmcnt(13)
    v_mfma_f32_16x16x32_bf16 v[124:127], v[20:23], v[52:55], 0
    buffer_load_dwordx4 v[52:55], v3, s[48:51], s58 offen nt
    s_add_u32 s58, s58, 9216
    s_waitcnt vmcnt(13)
    v_mfma_f32_16x16x32_bf16 v[124:127], v[24:27], v[56:59], v[124:127]
    buffer_load_dwordx4 v[56:59], v3, s[48:51], s58 offen nt
    s_add_u32 s58, s58, 9216
    s_waitcnt vmcnt(13)
    v_mfma_f32_16x16x32_bf16 v[124:127], v[28:31], v[60:63], v[124:127]
    buffer_load_dwordx4 v[60:63], v3, s[48:51], s58 offen nt
    s_add_u32 s58, s58, 9216
    s_waitcnt vmcnt(13)
    v_mfma_f32_16x16x32_bf16 v[124:127], v[32:35], v[64:67], v[124:127]
    buffer_load_dwordx4 v[64:67], v3, s[48:51], s58 offen nt
    s_add_u32 s58, s58, 9216
    s_waitcnt vmcnt(13)
    v_mfma_f32_16x16x32_bf16 v[124:127], v[36:39], v[68:71], v[124:127]
    buffer_load_dwordx4 v[68:71], v3, s[48:51], s58 offen nt
    s_add_u32 s58, s58, 9216
    s_waitcnt vmcnt(13)
    v_mfma_f32_16x16x32_bf16 v[124:127], v[40:43], v[72:75], v[124:127]
    buffer_load_dwordx4 v[72:75], v3, s[48:51], s58 offen nt
    s_waitcnt vmcnt(13)
    v_mfma_f32_16x16x32_bf16 v[124:127], v[44:47], v[76:79], v[124:127]
    s_mov_b32 s70, 80000
ML_21:
    ds_read_b128 v[84:87], v9 offset:3072
    ds_read_b32 v120, v11 offset:3072
    s_waitcnt lgkmcnt(0)
    v_min_u32 v121, v85, v87
    v_cmp_eq_u32 vcc, 0, v121
    s_nop 0
    s_cbranch_vccnz ML_23
ML_22:
    v_max_f32 v121, v84, v86
    s_nop 1
    v_max_f32_dpp v121, v121, v121 quad_perm:[1,0,3,2] row_mask:0xf bank_mask:0xf
    s_nop 1
    v_max_f32_dpp v121, v121, v121 quad_perm:[2,3,0,1] row_mask:0xf bank_mask:0xf
    s_nop 1
    v_max_f32_dpp v121, v121, v121 row_half_mirror row_mask:0xf bank_mask:0xf
    v_sub_f32 v120, v120, v121
    v_sub_f32 v84, v84, v121
    v_sub_f32 v86, v86, v121
    v_exp_f32 v84, v84
    v_exp_f32 v86, v86
    v_exp_f32 v120, v120
    v_mul_f32 v85, v84, v85
    v_fmac_f32 v85, v86, v87
    s_nop 1
    v_add_f32_dpp v85, v85, v85 quad_perm:[1,0,3,2] row_mask:0xf bank_mask:0xf
    s_nop 1
    v_add_f32_dpp v85, v85, v85 quad_perm:[2,3,0,1] row_mask:0xf bank_mask:0xf
    s_nop 1
    v_add_f32_dpp v85, v85, v85 row_half_mirror row_mask:0xf bank_mask:0xf
    v_rcp_f32 v84, v85
    v_log_f32 v85, v85
    v_mul_f32 v120, v120, v84
    v_add_f32 v121, v121, v85
    s_nop 0
    v_readlane_b32 s72, v121, s56
    s_nop 1
    v_mov_b32 v122, s72
    s_waitcnt vmcnt(12)
    v_mfma_f32_16x16x32_bf16 v[124:127], v[48:51], v[80:83], v[124:127]
    s_nop 7
    v_mul_f32 v124, v124, v120
    v_mul_f32 v125, v125, v120
    v_mul_f32 v126, v126, v120
    v_mul_f32 v127, v127, v120
    ds_write_b128 v17, v[124:127] offset:8192
    s_waitcnt lgkmcnt(0)
    s_barrier
    ds_read2_b32 v[120:121], v18 offset0:0 offset1:8
    ds_read2_b32 v[84:85], v19 offset0:0 offset1:8
    s_waitcnt lgkmcnt(0)
    v_add_f32 v120, v120, v84
    v_add_f32 v121, v121, v85
    s_nop 0
    v_add_f32_dpp v120, v120, v120 quad_perm:[1,0,3,2] row_mask:0xf bank_mask:0xf
    v_add_f32_dpp v121, v121, v121 quad_perm:[1,0,3,2] row_mask:0xf bank_mask:0xf
    s_nop 0
    v_add_f32_dpp v120, v120, v120 quad_perm:[2,3,0,1] row_mask:0xf bank_mask:0xf
    v_add_f32_dpp v121, v121, v121 quad_perm:[2,3,0,1] row_mask:0xf bank_mask:0xf
    s_nop 0
    v_add_f32_dpp v120, v120, v120 row_half_mirror row_mask:0xf bank_mask:0xf
    v_add_f32_dpp v121, v121, v121 row_half_mirror row_mask:0xf bank_mask:0xf
    s_mov_b32 exec_lo, 0x3030303
    s_mov_b32 exec_hi, 0x3030303
    buffer_store_dwordx4 v[120:123], v8, s[36:39], s57 offen sc1
    s_mov_b64 exec, -1
    v_lshlrev_b32 v15, 2, v14
    v_add_u32 v15, 3584, v15
    ds_read2_b32 v[20:21], v15 offset0:0 offset1:8
    ds_read2_b32 v[22:23], v15 offset0:16 offset1:24
    ds_read2_b32 v[24:25], v15 offset0:32 offset1:40
    ds_read2_b32 v[26:27], v15 offset0:48 offset1:56
    ds_read2_b32 v[28:29], v15 offset0:64 offset1:72
    ds_read2_b32 v[30:31], v15 offset0:80 offset1:88
    v_lshlrev_b32 v8, 6, v13
    v_and_b32 v16, 1, v10
    v_lshl_add_u32 v8, v16, 5, v8
    v_lshrrev_b32 v16, 1, v10
    v_lshl_add_u32 v8, v16, 4, v8
    s_mul_i32 s67, s69, 9
    s_add_u32 s67, s67, s3
    s_lshl_b32 s67, s67, 9
    s_add_u32 s67, s67, 213504
    v_mov_b32 v45, s60
    v_mov_b32 v47, s60
    s_waitcnt lgkmcnt(0)
    v_and_b32 v32, v20, v4
    v_and_b32 v33, v20, v5
    v_and_b32 v34, v20, v6
    v_and_b32 v35, v20, v7
    s_waitcnt vmcnt(12)
    s_nop 0
    v_mfma_f32_16x16x32_bf16 v[40:43], v[32:35], v[88:91], 0
    v_and_b32 v36, v21, v4
    v_and_b32 v37, v21, v5
    v_and_b32 v38, v21, v6
    v_and_b32 v39, v21, v7
    s_waitcnt vmcnt(11)
    s_nop 0
    v_mfma_f32_16x16x32_bf16 v[40:43], v[36:39], v[92:95], v[40:43]
    v_and_b32 v32, v22, v4
    v_and_b32 v33, v22, v5
    v_and_b32 v34, v22, v6
    v_and_b32 v35, v22, v7
    s_waitcnt vmcnt(10)
    s_nop 0
    v_mfma_f32_16x16x32_bf16 v[40:43], v[32:35], v[96:99], v[40:43]
    v_and_b32 v36, v23, v4
    v_and_b32 v37, v23, v5
    v_and_b32 v38, v23, v6
    v_and_b32 v39, v23, v7
    s_waitcnt vmcnt(9)
    s_nop 0
    v_mfma_f32_16x16x32_bf16 v[40:43], v[36:39], v[100:103], v[40:43]
    v_and_b32 v32, v24, v4
    v_and_b32 v33, v24, v5
    v_and_b32 v34, v24, v6
    v_and_b32 v35, v24, v7
    s_waitcnt vmcnt(8)
    s_nop 0
    v_mfma_f32_16x16x32_bf16 v[40:43], v[32:35], v[104:107], v[40:43]
    v_and_b32 v36, v25, v4
    v_and_b32 v37, v25, v5
    v_and_b32 v38, v25, v6
    v_and_b32 v39, v25, v7
    s_waitcnt vmcnt(7)
    s_nop 0
    v_mfma_f32_16x16x32_bf16 v[40:43], v[36:39], v[108:111], v[40:43]
    v_and_b32 v32, v26, v4
    v_and_b32 v33, v26, v5
    v_and_b32 v34, v26, v6
    v_and_b32 v35, v26, v7
    s_waitcnt vmcnt(6)
    s_nop 0
    v_mfma_f32_16x16x32_bf16 v[40:43], v[32:35], v[52:55], v[40:43]
    v_and_b32 v36, v27, v4
    v_and_b32 v37, v27, v5
    v_and_b32 v38, v27, v6
    v_and_b32 v39, v27, v7
    s_waitcnt vmcnt(5)
    s_nop 0
    v_mfma_f32_16x16x32_bf16 v[40:43], v[36:39], v[56:59], v[40:43]
    v_and_b32 v32, v28, v4
    v_and_b32 v33, v28, v5
    v_and_b32 v34, v28, v6
    v_and_b32 v35, v28, v7
    s_waitcnt vmcnt(4)
    s_nop 0
    v_mfma_f32_16x16x32_bf16 v[40:43], v[32:35], v[60:63], v[40:43]
    v_and_b32 v36, v29, v4
    v_and_b32 v37, v29, v5
    v_and_b32 v38, v29, v6
    v_and_b32 v39, v29, v7
    s_waitcnt vmcnt(3)
    s_nop 0
    v_mfma_f32_16x16x32_bf16 v[40:43], v[36:39], v[64:67], v[40:43]
    v_and_b32 v32, v30, v4
    v_and_b32 v33, v30, v5
    v_and_b32 v34, v30, v6
    v_and_b32 v35, v30, v7
    s_waitcnt vmcnt(2)
    s_nop 0
    v_mfma_f32_16x16x32_bf16 v[40:43], v[32:35], v[68:71], v[40:43]
    v_and_b32 v36, v31, v4
    v_and_b32 v37, v31, v5
    v_and_b32 v38, v31, v6
    v_and_b32 v39, v31, v7
    s_waitcnt vmcnt(1)
    s_nop 0
    v_mfma_f32_16x16x32_bf16 v[40:43], v[36:39], v[72:75], v[40:43]
    s_nop 7
    v_permlane32_swap_b32 v40, v42
    v_permlane32_swap_b32 v41, v43
    s_nop 0
    v_add_f32_dpp v44, v42, v40 row_ror:8 row_mask:0xf bank_mask:0xf
    v_add_f32_dpp v46, v43, v41 row_ror:8 row_mask:0xf bank_mask:0xf
    s_mov_b32 exec_lo, 0x00ff00ff
    s_mov_b32 exec_hi, 0x00ff00ff
    buffer_store_dwordx4 v[44:47], v8, s[36:39], s67 offen sc1
    s_endpgm
L_P:
    v_lshl_add_u32 v15, v13, 8, v16
    s_lshr_b32 s68, s62, 1
    s_lshl_b32 s68, 0x01010101, s68
    s_bitcmp1_b32 s62, 0
    s_cselect_b32 s64, s68, 0
    s_cselect_b32 s63, 0, s68
    s_sub_u32 s67, s3, 12
    v_lshrrev_b32 v1, 1, v10
    v_lshlrev_b32 v1, 10, v1
    v_lshl_add_u32 v1, v13, 5, v1
    v_and_b32 v2, 1, v10
    v_lshl_add_u32 v1, v2, 4, v1
    s_lshl_b32 s68, s67, 11
    s_lshr_b32 s72, s67, 1
    s_lshl_b32 s72, s72, 7
    s_add_u32 s68, s68, s72
    v_add_u32 v1, s68, v1
    v_lshrrev_b32 v3, 1, v0
    v_min_u32 v3, 23, v3
    v_and_b32 v2, 1, v0
    v_mul_u32_u24 v2, 4224, v2
    v_lshl_add_u32 v2, v3, 3, v2
    s_mul_i32 s68, s67, 192
    s_add_u32 s68, s68, 24832
    v_add_u32 v2, s68, v2
    v_lshrrev_b32 v12, 3, v3
    v_and_b32 v3, 7, v3
    v_lshlrev_b32 v3, 4, v3
    v_lshl_add_u32 v3, v12, 14, v3
    v_and_b32 v12, 1, v0
    v_lshl_add_u32 v3, v12, 13, v3
    v_and_b32 v12, 3, v0
    s_lshl2_add_u32 s68, s66, s67
    s_mul_i32 s68, s68, 6
    s_lshl2_add_u32 s68, s68, s65
    s_lshl4_add_u32 s68, s68, s61
    s_lshl_b32 s68, s68, 7
    s_add_u32 s58, s68, 458752
    s_waitcnt vmcnt(13)
    v_mfma_f32_16x16x32_bf16 v[124:127], v[20:23], v[52:55], 0
    s_waitcnt vmcnt(12)
    v_mfma_f32_16x16x32_bf16 v[124:127], v[24:27], v[56:59], v[124:127]
    s_waitcnt vmcnt(11)
    v_mfma_f32_16x16x32_bf16 v[124:127], v[28:31], v[60:63], v[124:127]
    s_waitcnt vmcnt(10)
    v_mfma_f32_16x16x32_bf16 v[124:127], v[32:35], v[64:67], v[124:127]
    v_xor_b32 v84, s60, v84
    v_cmp_eq_u32 vcc, 1, v84
    v_cmp_eq_u32 s[66:67], 0, v84
    s_getreg_b32 s72, hwreg(HW_REG_XCC_ID, 2, 1)
    s_bcnt1_i32_b64 s68, vcc
    s_bcnt1_i32_b64 s69, s[66:67]
    s_cmp_gt_u32 s68, s69
    s_cselect_b32 s18, 1, 0
    s_xor_b32 s18, s18, s72
    s_lshl_b32 s18, s18, 13
    s_add_u32 s71, s71, s18
    s_waitcnt vmcnt(9)
    v_mfma_f32_16x16x32_bf16 v[124:127], v[36:39], v[68:71], v[124:127]
    s_waitcnt vmcnt(8)
    v_mfma_f32_16x16x32_bf16 v[124:127], v[40:43], v[72:75], v[124:127]
    s_waitcnt vmcnt(7)
    v_mfma_f32_16x16x32_bf16 v[124:127], v[44:47], v[76:79], v[124:127]
    s_mov_b32 s70, 80000
ML_24:
    ds_read_b128 v[84:87], v9 offset:3072
    ds_read_b32 v120, v11 offset:3072
    s_waitcnt lgkmcnt(0)
    v_min_u32 v121, v85, v87
    v_cmp_eq_u32 vcc, 0, v121
    s_nop 0
    s_cbranch_vccnz ML_26
ML_25:
    v_max_f32 v121, v84, v86
    s_nop 1
    v_max_f32_dpp v121, v121, v121 quad_perm:[1,0,3,2] row_mask:0xf bank_mask:0xf
    s_nop 1
    v_max_f32_dpp v121, v121, v121 quad_perm:[2,3,0,1] row_mask:0xf bank_mask:0xf
    s_nop 1
    v_max_f32_dpp v121, v121, v121 row_half_mirror row_mask:0xf bank_mask:0xf
    v_sub_f32 v120, v120, v121
    v_sub_f32 v84, v84, v121
    v_sub_f32 v86, v86, v121
    v_exp_f32 v84, v84
    v_exp_f32 v86, v86
    v_exp_f32 v120, v120
    v_mul_f32 v85, v84, v85
    v_fmac_f32 v85, v86, v87
    s_nop 1
    v_add_f32_dpp v85, v85, v85 quad_perm:[1,0,3,2] row_mask:0xf bank_mask:0xf
    s_nop 1
    v_add_f32_dpp v85, v85, v85 quad_perm:[2,3,0,1] row_mask:0xf bank_mask:0xf
    s_nop 1
    v_add_f32_dpp v85, v85, v85 row_half_mirror row_mask:0xf bank_mask:0xf
    v_rcp_f32 v84, v85
    v_log_f32 v85, v85
    v_mul_f32 v120, v120, v84
    v_add_f32 v121, v121, v85
    s_nop 0
    v_readlane_b32 s72, v121, s56
    s_nop 1
    v_mov_b32 v122, s72
    s_waitcnt vmcnt(6)
    v_mfma_f32_16x16x32_bf16 v[124:127], v[48:51], v[80:83], v[124:127]
    s_nop 7
    v_mul_f32 v124, v124, v120
    v_mul_f32 v125, v125, v120
    v_mul_f32 v126, v126, v120
    v_mul_f32 v127, v127, v120
    ds_write_b128 v17, v[124:127] offset:8192
    s_waitcnt lgkmcnt(0)
    s_barrier
    ds_read2_b32 v[120:121], v18 offset0:0 offset1:8
    ds_read2_b32 v[84:85], v19 offset0:0 offset1:8
    s_waitcnt lgkmcnt(0)
    v_add_f32 v120, v120, v84
    v_add_f32 v121, v121, v85
    s_nop 0
    v_add_f32_dpp v120, v120, v120 quad_perm:[1,0,3,2] row_mask:0xf bank_mask:0xf
    v_add_f32_dpp v121, v121, v121 quad_perm:[1,0,3,2] row_mask:0xf bank_mask:0xf
    s_nop 0
    v_add_f32_dpp v120, v120, v120 quad_perm:[2,3,0,1] row_mask:0xf bank_mask:0xf
    v_add_f32_dpp v121, v121, v121 quad_perm:[2,3,0,1] row_mask:0xf bank_mask:0xf
    s_nop 0
    v_add_f32_dpp v120, v120, v120 row_half_mirror row_mask:0xf bank_mask:0xf
    v_add_f32_dpp v121, v121, v121 row_half_mirror row_mask:0xf bank_mask:0xf
    s_mov_b32 exec_lo, 0x3030303
    s_mov_b32 exec_hi, 0x3030303
    buffer_store_dwordx4 v[120:123], v8, s[36:39], s57 offen sc1
    s_not_b32 exec_lo, s63
    s_not_b32 exec_hi, s63
    buffer_load_dwordx4 v[112:115], v15, s[36:39], s71 offen offset:0 sc0 sc1
    s_not_b32 exec_lo, s64
    s_not_b32 exec_hi, s64
    buffer_load_dwordx4 v[116:119], v15, s[36:39], s71 offen offset:128 sc0 sc1
    s_mov_b64 exec, -1
    s_mov_b32 exec_lo, s63
    s_mov_b32 exec_hi, s63
    v_mov_b32 v112, v120
    v_mov_b32 v113, v121
    v_mov_b32 v114, v122
    v_mov_b32 v115, v123
    s_mov_b32 exec_lo, s64
    s_mov_b32 exec_hi, s64
    v_mov_b32 v116, v120
    v_mov_b32 v117, v121
    v_mov_b32 v118, v122
    v_mov_b32 v119, v123
    s_mov_b64 exec, -1
    s_waitcnt vmcnt(0)
    v_mov_b32 v49, s60
    v_mov_b32 v51, s60
    s_mov_b32 s70, 20000
PC_27:
    v_cmp_ne_u32 vcc, s60, v115
    v_cmp_ne_u32 s[68:69], s60, v119
    s_nop 0
    s_or_b64 s[66:67], vcc, s[68:69]
    s_cbranch_scc1 PR_28
PD_29:
    v_max_f32 v20, v114, v118
    s_nop 1
    v_max_f32_dpp v20, v20, v20 quad_perm:[1,0,3,2] row_mask:0xf bank_mask:0xf
    s_nop 1
    v_max_f32_dpp v20, v20, v20 quad_perm:[2,3,0,1] row_mask:0xf bank_mask:0xf
    s_nop 1
    v_max_f32_dpp v20, v20, v20 row_half_mirror row_mask:0xf bank_mask:0xf
    v_sub_f32 v114, v114, v20
    v_sub_f32 v118, v118, v20
    v_exp_f32 v114, v114
    v_exp_f32 v118, v118
    v_mul_f32 v112, v112, v114
    v_mul_f32 v113, v113, v114
    v_add_f32 v114, v114, v118
    v_fmac_f32 v112, v116, v118
    v_fmac_f32 v113, v117, v118
    v_add_f32_dpp v114, v114, v114 quad_perm:[1,0,3,2] row_mask:0xf bank_mask:0xf
    v_add_f32_dpp v112, v112, v112 quad_perm:[1,0,3,2] row_mask:0xf bank_mask:0xf
    v_add_f32_dpp v113, v113, v113 quad_perm:[1,0,3,2] row_mask:0xf bank_mask:0xf
    v_add_f32_dpp v114, v114, v114 quad_perm:[2,3,0,1] row_mask:0xf bank_mask:0xf
    v_add_f32_dpp v112, v112, v112 quad_perm:[2,3,0,1] row_mask:0xf bank_mask:0xf
    v_add_f32_dpp v113, v113, v113 quad_perm:[2,3,0,1] row_mask:0xf bank_mask:0xf
    v_add_f32_dpp v114, v114, v114 row_half_mirror row_mask:0xf bank_mask:0xf
    v_add_f32_dpp v112, v112, v112 row_half_mirror row_mask:0xf bank_mask:0xf
    v_add_f32_dpp v113, v113, v113 row_half_mirror row_mask:0xf bank_mask:0xf
    v_rcp_f32 v114, v114
    s_nop 0
    v_mul_f32 v112, v112, v114
    v_mul_f32 v113, v113, v114
    v_cvt_pk_bf16_f32 v112, v112, v112
    v_cvt_pk_bf16_f32 v113, v113, v113
    v_and_b32 v36, v112, v4
    v_and_b32 v37, v112, v5
    v_and_b32 v38, v112, v6
    v_and_b32 v39, v112, v7
    s_nop 1
    v_mfma_f32_16x16x32_bf16 v[52:55], v[36:39], v[88:91], 0
    v_and_b32 v40, v113, v4
    v_and_b32 v41, v113, v5
    v_and_b32 v42, v113, v6
    v_and_b32 v43, v113, v7
    v_mfma_f32_16x16x32_bf16 v[56:59], v[36:39], v[96:99], 0
    v_mfma_f32_16x16x32_bf16 v[60:63], v[36:39], v[104:107], 0
    v_mfma_f32_16x16x32_bf16 v[52:55], v[40:43], v[92:95], v[52:55]
    v_mfma_f32_16x16x32_bf16 v[56:59], v[40:43], v[100:103], v[56:59]
    v_mfma_f32_16x16x32_bf16 v[60:63], v[40:43], v[108:111], v[60:63]
    s_mov_b32 exec_lo, 0x00ff00ff
    s_mov_b32 exec_hi, 0xff00ff00
    s_nop 3
    ds_write_b128 v1, v[52:55] offset:24832
    ds_write_b128 v1, v[56:59] offset:25088
    ds_write_b128 v1, v[60:63] offset:25344
    s_mov_b64 exec, -1
    s_waitcnt lgkmcnt(0)
    s_barrier
    ds_read2st64_b64 v[20:23], v2 offset0:0 offset1:2
    ds_read2st64_b64 v[24:27], v2 offset0:4 offset1:6
    s_waitcnt lgkmcnt(1)
    v_add_f32 v20, v20, v22
    v_add_f32 v21, v21, v23
    s_waitcnt lgkmcnt(0)
    v_add_f32 v24, v24, v26
    v_add_f32 v25, v25, v27
    v_add_f32 v20, v20, v24
    v_add_f32 v21, v21, v25
    s_nop 0
    v_add_f32_dpp v48, v20, v20 quad_perm:[1,0,3,2] row_mask:0xf bank_mask:0xf
    v_add_f32_dpp v50, v21, v21 quad_perm:[1,0,3,2] row_mask:0xf bank_mask:0xf
    s_mov_b32 exec_hi, 0x0000ffff
    buffer_store_dwordx4 v[48:51], v3, s[36:39], s58 offen sc1
    s_cmp_lg_u32 s3, 12
    s_cbranch_scc1 L_exit
    s_cmp_ge_u32 s2, 72
    s_cbranch_scc1 L_exit
    s_mov_b64 exec, -1
    s_lshr_b32 s68, s2, 1
    s_lshl_b32 s68, s68, 14
    s_and_b32 s67, s2, 1
    s_lshl_b32 s67, s67, 6
    s_add_u32 s68, s68, s67
    s_add_u32 s68, s68, s18
    v_lshrrev_b32 v9, 2, v0
    v_mul_u32_u24 v15, 128, v9
    v_lshl_add_u32 v15, v12, 4, v15
    v_mul_u32_u24 v9, 4608, v9
    v_lshl_add_u32 v9, v12, 4, v9
    s_lshl_b32 s56, s2, 6
    s_add_u32 s57, s68, 458752
    s_add_u32 s56, s56, 217088
    s_add_u32 s61, s57, 2048
    s_add_u32 s62, s57, 4096
    s_add_u32 s63, s57, 6144
    buffer_load_dwordx4 v[68:71], v9, s[36:39], s56 offen sc0 sc1
    s_add_u32 s67, s56, 73728
    buffer_load_dwordx4 v[72:75], v9, s[36:39], s67 offen sc0 sc1
    s_add_u32 s67, s56, 147456
    buffer_load_dwordx4 v[76:79], v9, s[36:39], s67 offen sc0 sc1
    v_lshlrev_b32 v17, 2, v12
    s_lshl_b32 s59, s2, 4
    buffer_load_dword v18, v17, s[44:47], s59 offen
    buffer_load_dwordx4 v[52:55], v15, s[36:39], s57 offen sc0 sc1
    buffer_load_dwordx4 v[56:59], v15, s[36:39], s61 offen sc0 sc1
    buffer_load_dwordx4 v[60:63], v15, s[36:39], s62 offen sc0 sc1
    buffer_load_dwordx4 v[64:67], v15, s[36:39], s63 offen sc0 sc1
    s_mov_b32 s52, s22
    s_and_b32 s53, s23, 0xffff
    s_mov_b32 s54, 1152
    s_mov_b32 s55, 0x20000
    s_waitcnt vmcnt(4)
    s_mov_b32 s70, 20000
PC_32:
    v_bitop3_b32 v20, v71, v75, s60 bitop3:0x7e
    v_bitop3_b32 v21, v79, v79, s60 bitop3:0x7e
    v_or_b32 v20, v20, v21
    v_cmp_ne_u32 vcc, 0, v20
    s_nop 0
    s_cbranch_vccnz PR_33
PD_34:
    v_add_f32 v68, v68, v72
    v_add_f32 v70, v70, v74
    v_add_f32 v68, v68, v76
    v_add_f32 v70, v70, v78
    s_nop 0
    v_add_f32_dpp v68, v68, v68 row_ror:4 row_mask:0xf bank_mask:0xf
    v_add_f32_dpp v70, v70, v70 row_ror:4 row_mask:0xf bank_mask:0xf
    s_nop 0
    v_add_f32_dpp v68, v68, v68 row_ror:8 row_mask:0xf bank_mask:0xf
    v_add_f32_dpp v70, v70, v70 row_ror:8 row_mask:0xf bank_mask:0xf
    v_mov_b32 v69, v68
    v_mov_b32 v71, v70
    s_nop 0
    v_permlane16_swap_b32 v69, v68
    v_permlane16_swap_b32 v71, v70
    v_add_f32 v68, v68, v69
    v_add_f32 v70, v70, v71
    v_mov_b32 v69, v68
    v_mov_b32 v71, v70
    s_nop 0
    v_permlane32_swap_b32 v69, v68
    v_permlane32_swap_b32 v71, v70
    v_add_f32 v68, v68, v69
    v_add_f32 v70, v70, v71
    v_cvt_pk_bf16_f32 v68, v68, v68
    v_and_b32 v68, 0xffff0000, v68
    v_cvt_pk_bf16_f32 v70, v70, v70
    v_and_b32 v70, 0xffff0000, v70
    v_mul_f32 v69, 0xbfb8aa3b, v68
    v_exp_f32 v69, v69
    s_nop 0
    v_add_f32 v69, 1.0, v69
    v_rcp_f32 v69, v69
    s_nop 0
    v_mul_f32 v68, v68, v69
    v_mul_f32 v71, 0xbfb8aa3b, v70
    v_exp_f32 v71, v71
    s_nop 0
    v_add_f32 v71, 1.0, v71
    v_rcp_f32 v71, v71
    s_nop 0
    v_mul_f32 v70, v70, v71
    v_cvt_pk_bf16_f32 v68, v68, v68
    v_and_b32 v68, 0xffff0000, v68
    v_cvt_pk_bf16_f32 v70, v70, v70
    v_and_b32 v70, 0xffff0000, v70
    v_and_b32 v19, 0xffff0000, v18
    v_lshlrev_b32 v18, 16, v18
    s_waitcnt vmcnt(0)
    s_mov_b32 s70, 20000
PC_35:
    v_bitop3_b32 v20, v55, v59, s60 bitop3:0x7e
    v_bitop3_b32 v21, v63, v67, s60 bitop3:0x7e
    v_or_b32 v20, v20, v21
    v_cmp_ne_u32 vcc, 0, v20
    s_nop 0
    s_cbranch_vccnz PR_36
PD_37:
    v_add_f32 v52, v52, v56
    v_add_f32 v54, v54, v58
    v_add_f32 v60, v60, v64
    v_add_f32 v62, v62, v66
    v_add_f32 v52, v52, v60
    v_add_f32 v54, v54, v62
    s_nop 0
    v_add_f32_dpp v52, v52, v52 row_ror:4 row_mask:0xf bank_mask:0xf
    v_add_f32_dpp v54, v54, v54 row_ror:4 row_mask:0xf bank_mask:0xf
    s_nop 0
    v_add_f32_dpp v52, v52, v52 row_ror:8 row_mask:0xf bank_mask:0xf
    v_add_f32_dpp v54, v54, v54 row_ror:8 row_mask:0xf bank_mask:0xf
    v_mov_b32 v53, v52
    v_mov_b32 v55, v54
    s_nop 0
    v_permlane16_swap_b32 v53, v52
    v_permlane16_swap_b32 v55, v54
    v_add_f32 v52, v52, v53
    v_add_f32 v54, v54, v55
    v_mov_b32 v53, v52
    v_mov_b32 v55, v54
    s_nop 0
    v_permlane32_swap_b32 v53, v52
    v_permlane32_swap_b32 v55, v54
    v_add_f32 v52, v52, v53
    v_add_f32 v54, v54, v55
    v_cvt_pk_bf16_f32 v52, v52, v52
    v_and_b32 v52, 0xffff0000, v52
    v_cvt_pk_bf16_f32 v54, v54, v54
    v_and_b32 v54, 0xffff0000, v54
    v_mul_f32 v52, v52, v68
    v_mul_f32 v54, v54, v70
    v_cvt_pk_bf16_f32 v52, v52, v52
    v_and_b32 v52, 0xffff0000, v52
    v_cvt_pk_bf16_f32 v54, v54, v54
    v_and_b32 v54, 0xffff0000, v54
    v_add_f32 v52, v52, v18
    v_add_f32 v54, v54, v19
    v_cvt_pk_bf16_f32 v52, v52, v54
    s_mov_b64 exec, 15
    buffer_store_dword v52, v17, s[52:55], s59 offen
    s_cmp_lg_u32 s2, 0
    s_cbranch_scc1 L_exit
    s_mov_b64 exec, 1
    v_mov_b32 v56, s60
    buffer_store_dword v56, v17, s[36:39], 0 offen sc1
L_exit:
L_end:
    s_endpgm
L_qD:
    buffer_load_dwordx4 v[76:79], v1, s[32:35], s64 offen offset:1024 nt
    buffer_load_dwordx4 v[80:83], v1, s[32:35], s64 offen offset:2048 nt
    s_waitcnt vmcnt(4)
    s_setprio 3
    buffer_load_dwordx4 v[88:91], v108, s[36:39], s67 offen sc0 sc1
    s_waitcnt vmcnt(0)
    s_branch L_q1
PR_8:
    s_sub_u32 s70, s70, 1
    s_nop 0
    s_cbranch_scc1 PD_9
    s_sleep 1
    s_wqm_b64 exec, vcc
    buffer_load_dwordx4 v[88:91], v108, s[36:39], s67 offen sc0 sc1
    s_mov_b64 exec, -1
    s_waitcnt vmcnt(0)
    s_branch PC_7
L_qr:
    s_sub_u32 s70, s70, 1
    s_nop 0
    s_cbranch_scc1 L_qd
    s_sleep 4
    s_branch L_qs
ML_14:
    s_sub_u32 s70, s70, 1
    s_nop 0
    s_cbranch_scc1 ML_13
    s_sleep 2
    s_branch ML_12
ML_17:
    s_sub_u32 s70, s70, 1
    s_nop 0
    s_cbranch_scc1 ML_16
    s_sleep 2
    s_branch ML_15
PR_19:
    s_sub_u32 s70, s70, 1
    s_nop 0
    s_cbranch_scc1 PD_20
    s_sleep 1
    s_wqm_b64 exec, vcc
    buffer_load_dwordx4 v[88:91], v108, s[36:39], s58 offen sc0 sc1
    s_mov_b64 exec, -1
    s_waitcnt vmcnt(0)
    s_branch PC_18
ML_23:
    s_sub_u32 s70, s70, 1
    s_nop 0
    s_cbranch_scc1 ML_22
    s_sleep 2
    s_branch ML_21
ML_26:
    s_sub_u32 s70, s70, 1
    s_nop 0
    s_cbranch_scc1 ML_25
    s_sleep 2
    s_branch ML_24
PR_28:
    s_sub_u32 s70, s70, 1
    s_cbranch_scc1 PD_29
    s_sleep 1
    s_mov_b64 exec, vcc
    s_cbranch_execz PS_30
    buffer_load_dwordx4 v[112:115], v15, s[36:39], s71 offen offset:0 sc0 sc1
PS_30:
    s_mov_b64 exec, s[68:69]
    s_cbranch_execz PS_31
    buffer_load_dwordx4 v[116:119], v15, s[36:39], s71 offen offset:128 sc0 sc1
PS_31:
    s_mov_b64 exec, -1
    s_waitcnt vmcnt(0)
    s_branch PC_27
PR_33:
    s_sub_u32 s70, s70, 1
    s_nop 0
    s_cbranch_scc1 PD_34
    s_sleep 1
    s_mov_b64 exec, vcc
    buffer_load_dwordx4 v[68:71], v9, s[36:39], s56 offen sc0 sc1
    s_add_u32 s67, s56, 73728
    buffer_load_dwordx4 v[72:75], v9, s[36:39], s67 offen sc0 sc1
    s_add_u32 s67, s56, 147456
    buffer_load_dwordx4 v[76:79], v9, s[36:39], s67 offen sc0 sc1
    s_mov_b64 exec, -1
    s_waitcnt vmcnt(0)
    s_branch PC_32
PR_36:
    s_sub_u32 s70, s70, 1
    s_nop 0
    s_cbranch_scc1 PD_37
    s_sleep 1
    s_mov_b64 exec, vcc
    buffer_load_dwordx4 v[52:55], v15, s[36:39], s57 offen sc0 sc1
    buffer_load_dwordx4 v[56:59], v15, s[36:39], s61 offen sc0 sc1
    buffer_load_dwordx4 v[60:63], v15, s[36:39], s62 offen sc0 sc1
    buffer_load_dwordx4 v[64:67], v15, s[36:39], s63 offen sc0 sc1
    s_mov_b64 exec, -1
    s_waitcnt vmcnt(0)
    s_branch PC_35
.section .rodata,"a"
.p2align 6
.amdhsa_kernel recurrent_scan__gqa_block_cached__swiglu_ffn__decode_kernel
  .amdhsa_next_free_vgpr 128
  .amdhsa_next_free_sgpr 102
  .amdhsa_accum_offset 128
  .amdhsa_group_segment_fixed_size 0
  .amdhsa_kernarg_size 96
  .amdhsa_user_sgpr_count 2
  .amdhsa_user_sgpr_kernarg_segment_ptr 1
  .amdhsa_system_sgpr_workgroup_id_x 1
  .amdhsa_float_denorm_mode_32 3
  .amdhsa_float_denorm_mode_16_64 3
.end_amdhsa_kernel
```
